```python
import torch

def _softmax(x, axis=-1):
    return torch.softmax(x, dim=axis)
def _gelu(x):
    return torch.nn.functional.gelu(x, approximate="tanh")
def _silu(x):
    return torch.nn.functional.silu(x)
def _sigmoid(x):
    return torch.sigmoid(x)
def _layernorm(x, axis=-1, eps=1e-5):
    m = x.mean(dim=axis, keepdim=True)
    v = x.var(dim=axis, keepdim=True, unbiased=False)
    return (x - m) / torch.sqrt(v + eps)
def _scatter_add(tgt, idx, src, axis=0):
    return tgt.clone().index_add_(axis, idx, src)
def _segment_sum(src, seg, n):
    out = torch.zeros((n,) + src.shape[1:], dtype=src.dtype)
    return out.index_add_(0, seg, src)
def _pad(x, pw):
    flat = tuple(v for pair in reversed(pw) for v in pair)
    return torch.nn.functional.pad(x, flat)

kernel_name = 'standalone__sliding_block__prompt'

def setup_inputs():

    _w = (lambda a: (lambda t: t.to(torch.bfloat16) if t.is_floating_point() else t)(torch.as_tensor(a)))
    B, S, D = 1, 2048, 640
    return {
        "x": _w((lambda *s: torch.randn(*s, dtype=torch.bfloat16) * 0.2)(B, S, D)),
        "wqkv": _w((lambda *s: torch.randn(*s, dtype=torch.bfloat16) * 0.2)(D, 3 * D)),
        "wo": _w((lambda *s: torch.randn(*s, dtype=torch.bfloat16) * 0.05)(D, D)),
    }

def reference(x, wqkv, wo):
    B, S, D = x.shape
    H = 32; Dh = D // H; W = 256
    qkv = (lambda x, *d: x.permute(*d))((x @ wqkv).reshape(B, S, 3, H, Dh), 2, 0, 3, 1, 4)
    q, k, v = qkv[0], qkv[1], qkv[2]
    scores = torch.einsum("bhqd,bhkd->bhqk", q, k) * (Dh ** -0.5)
    idx = torch.arange(S)
    mask = (idx[:, None] - idx[None, :] >= 0) & (idx[:, None] - idx[None, :] < W)
    scores = torch.where(mask[None, None], scores, -1e9)
    p = _softmax(scores, axis=-1)
    o = torch.einsum("bhqk,bhkd->bhqd", p, v)
    return (lambda x, *d: x.permute(*d))(o, 0, 2, 1, 3).reshape(B, S, D) @ wo
```

```asm
; @launch grid=(256,1,1) block=(512,1,1) lds=163840
.amdgcn_target "amdgcn-amd-amdhsa--gfx950"
.text
.globl standalone__sliding_block__prompt_kernel
.p2align 8
.type standalone__sliding_block__prompt_kernel,@function
standalone__sliding_block__prompt_kernel:
    s_cmp_ge_u32 s2, 256
    s_cbranch_scc1 L_end
    s_load_dwordx8 s[4:11], s[0:1], 0
    s_load_dwordx4 s[12:15], s[0:1], 32
    v_lshrrev_b32 v1, 6, v0
    v_and_b32 v0, 63, v0
    v_readfirstlane_b32 s36, v1
    s_and_b32 s37, s2, 7
    s_lshr_b32 s38, s2, 3
    s_and_b32 s46, s37, 3
    s_lshl_b32 s46, s46, 2
    s_and_b32 s47, s38, 3
    s_lshr_b32 s48, s37, 2
    s_lshr_b32 s42, s38, 2
    s_lshl_b32 s49, s48, 3
    s_add_u32 s40, s49, s42
    s_lshl_b32 s49, s48, 1
    s_add_u32 s49, s49, s47
    s_cmp_ge_u32 s38, 28
    s_cselect_b32 s40, 7, s40
    s_cselect_b32 s49, s49, s47
    s_add_u32 s39, s46, s49
    s_cmp_ge_u32 s38, 30
    s_cselect_b32 s40, 15, s40
    s_lshl_b32 s41, s37, 2
    s_add_u32 s41, s41, s47
    s_and_b32 s43, s41, 1
    s_mov_b32 s54, 0
    s_mov_b32 s55, -1
    s_cmp_lt_u32 s38, 30
    s_cbranch_scc1 L_nopf
    s_getpc_b64 s[48:49]
    s_lshl_b32 s46, s36, 12
    v_lshlrev_b32 v2, 6, v0
    v_add_u32 v2, s46, v2
    v_min_u32 v2, L_code_end - L_nopf, v2
    global_load_dword v255, v2, s[48:49]
L_nopf:
    s_cmp_lt_u32 s36, 4
    s_cbranch_scc1 L_compute
    s_mov_b32 s61, 1
    s_sub_u32 s46, s36, 4
    v_lshrrev_b32 v2, 3, v0
    v_mul_u32_u24 v2, 1280, v2
    s_and_b32 s47, s46, 1
    s_lshl_b32 s47, s47, 2
    v_lshrrev_b32 v3, 4, v0
    v_add_u32 v4, s47, v3
    v_and_b32 v5, 7, v0
    v_xor_b32 v4, v4, v5
    v_lshl_add_u32 v2, v4, 4, v2
    s_mul_i32 s48, s39, 81920
    s_mul_i32 s49, s46, 10240
    s_add_u32 s48, s48, s49
    v_add_u32 v240, s48, v2
    v_mul_u32_u24 v4, 3840, v3
    v_lshlrev_b32 v5, 2, v3
    v_and_b32 v6, 15, v0
    v_xor_b32 v5, v5, v6
    v_lshl_add_u32 v3, v5, 4, v4
    s_lshl_b32 s48, s40, 8
    s_mul_i32 s49, s46, 15360
    s_add_u32 s48, s48, s49
    v_add_u32 v241, s48, v3
    s_lshl_b32 s45, s46, 10
    s_lshl_b32 s47, s37, 2
    s_lshr_b32 s96, 0x30858530, s47
    s_and_b32 s96, s96, 15
    s_and_b32 s47, s38, 3
    s_add_u32 s47, s47, s42
    s_and_b32 s47, s47, 1
    s_add_u32 s96, s96, s47
    s_waitcnt lgkmcnt(0)
    s_mov_b32 s16, s4
    s_mov_b32 s17, s5
    s_mov_b32 s18, 2621440
    s_mov_b32 s19, 0x20000
    s_mov_b32 s20, s6
    s_mov_b32 s21, s7
    s_mov_b32 s22, 2457600
    s_mov_b32 s23, 0x20000
    s_cmp_ge_u32 s40, 15
    s_cbranch_scc1 L_ld_idle
    s_mul_i32 s97, s96, 245760
    s_add_u32 m0, s45, 0
    s_add_u32 s51, s97, 0
    buffer_load_dwordx4 v241, s[20:23], s51 offen lds
    s_add_u32 m0, s45, 4096
    s_add_u32 s51, s97, 61440
    buffer_load_dwordx4 v241, s[20:23], s51 offen lds
    s_add_u32 m0, s45, 8192
    s_add_u32 s51, s97, 122880
    buffer_load_dwordx4 v241, s[20:23], s51 offen lds
    s_add_u32 m0, s45, 12288
    s_add_u32 s51, s97, 184320
    buffer_load_dwordx4 v241, s[20:23], s51 offen lds
    s_lshl_b32 s97, s96, 7
    s_add_u32 m0, s45, 16384
    s_add_u32 s51, s97, 0
    buffer_load_dwordx4 v240, s[16:19], s51 offen lds
    s_add_u32 m0, s45, 20480
    s_add_u32 s51, s97, 40960
    buffer_load_dwordx4 v240, s[16:19], s51 offen lds
    s_add_u32 s96, s96, 1
    s_cmp_ge_u32 s96, 10
    s_cselect_b32 s96, 0, s96
    s_mul_i32 s97, s96, 245760
    s_add_u32 m0, s45, 24576
    s_add_u32 s51, s97, 0
    buffer_load_dwordx4 v241, s[20:23], s51 offen lds
    s_add_u32 m0, s45, 28672
    s_add_u32 s51, s97, 61440
    buffer_load_dwordx4 v241, s[20:23], s51 offen lds
    s_add_u32 m0, s45, 32768
    s_add_u32 s51, s97, 122880
    buffer_load_dwordx4 v241, s[20:23], s51 offen lds
    s_add_u32 m0, s45, 36864
    s_add_u32 s51, s97, 184320
    buffer_load_dwordx4 v241, s[20:23], s51 offen lds
    s_lshl_b32 s97, s96, 7
    s_add_u32 m0, s45, 40960
    s_add_u32 s51, s97, 0
    buffer_load_dwordx4 v240, s[16:19], s51 offen lds
    s_add_u32 m0, s45, 45056
    s_add_u32 s51, s97, 40960
    buffer_load_dwordx4 v240, s[16:19], s51 offen lds
    s_add_u32 s96, s96, 1
    s_cmp_ge_u32 s96, 10
    s_cselect_b32 s96, 0, s96
    s_mul_i32 s97, s96, 245760
    s_add_u32 m0, s45, 49152
    s_add_u32 s51, s97, 0
    buffer_load_dwordx4 v241, s[20:23], s51 offen lds
    s_add_u32 m0, s45, 53248
    s_add_u32 s51, s97, 61440
    buffer_load_dwordx4 v241, s[20:23], s51 offen lds
    s_add_u32 m0, s45, 57344
    s_add_u32 s51, s97, 122880
    buffer_load_dwordx4 v241, s[20:23], s51 offen lds
    s_add_u32 m0, s45, 61440
    s_add_u32 s51, s97, 184320
    buffer_load_dwordx4 v241, s[20:23], s51 offen lds
    s_lshl_b32 s97, s96, 7
    s_add_u32 m0, s45, 65536
    s_add_u32 s51, s97, 0
    buffer_load_dwordx4 v240, s[16:19], s51 offen lds
    s_add_u32 m0, s45, 69632
    s_add_u32 s51, s97, 40960
    buffer_load_dwordx4 v240, s[16:19], s51 offen lds
    s_add_u32 s96, s96, 1
    s_cmp_ge_u32 s96, 10
    s_cselect_b32 s96, 0, s96
    s_mov_b32 s32, s14
    s_mov_b32 s33, s15
    s_mov_b32 s34, 14680064
    s_mov_b32 s35, 0x20000
    s_branch L_prep
L_ld_idle:
    s_mov_b32 s32, s14
    s_mov_b32 s33, s15
    s_mov_b32 s34, 14680064
    s_mov_b32 s35, 0x20000
    s_mov_b32 s24, s8
    s_mov_b32 s25, s9
    s_mov_b32 s26, 819200
    s_mov_b32 s27, 0x20000
    v_lshlrev_b32 v2, 4, v0
    s_mov_b32 m0, s45
    s_and_b32 s47, s38, 1
    s_lshl_b32 s48, s47, 3
    s_add_u32 s48, s48, s37
    s_mul_i32 s46, s48, 81920
    s_add_u32 s46, s46, 1310720
    s_add_u32 s46, s46, s45
    s_mov_b32 s49, 0
L_xw:
    buffer_load_dwordx4 v2, s[16:19], s46 offen lds
    s_add_u32 s46, s46, 4096
    s_add_u32 s49, s49, 1
    s_waitcnt vmcnt(12)
    s_cmp_lt_u32 s49, 20
    s_cbranch_scc1 L_xw
    s_mul_i32 s46, s47, 409600
    s_mul_i32 s49, s37, 49152
    s_add_u32 s46, s46, s49
    s_add_u32 s46, s46, s45
    s_mov_b32 s49, 0
L_warm:
    buffer_load_dwordx4 v2, s[24:27], s46 offen lds
    s_add_u32 s46, s46, 4096
    s_add_u32 s49, s49, 1
    s_cmp_ge_u32 s46, 819200
    s_cselect_b32 s46, s45, s46
    s_waitcnt vmcnt(12)
    s_cmp_lt_u32 s49, 14
    s_cbranch_scc1 L_warm
    s_waitcnt vmcnt(0)
    s_branch L_prep
L_compute:
    s_mov_b32 s61, 0
    v_and_b32 v16, 31, v0
    v_lshrrev_b32 v17, 5, v0
    v_bfe_u32 v18, v0, 1, 3
    v_xor_b32 v18, v18, v17
    v_lshlrev_b32 v19, 7, v16
    v_xor_b32 v20, 0, v18
    v_lshl_add_u32 v2, v20, 4, v19
    v_add_u32 v6, 49152, v2
    v_xor_b32 v20, 2, v18
    v_lshl_add_u32 v3, v20, 4, v19
    v_add_u32 v7, 49152, v3
    v_xor_b32 v20, 4, v18
    v_lshl_add_u32 v4, v20, 4, v19
    v_add_u32 v8, 49152, v4
    v_xor_b32 v20, 6, v18
    v_lshl_add_u32 v5, v20, 4, v19
    v_add_u32 v9, 49152, v5
    v_bfe_u32 v20, v0, 2, 2
    v_lshl_add_u32 v21, v17, 3, v20
    v_lshlrev_b32 v21, 8, v21
    v_bfe_u32 v22, v0, 4, 1
    v_bfe_u32 v23, v0, 1, 1
    v_lshl_add_u32 v22, v22, 1, v23
    v_and_b32 v23, 1, v0
    v_lshl_add_u32 v21, v23, 3, v21
    v_lshl_add_u32 v21, v22, 4, v21
    v_xor_b32 v22, s36, v20
    v_lshl_add_u32 v10, v22, 6, v21
    v_add_u32 v11, 49152, v10
    v_lshlrev_b32 v12, 4, v0
    v_lshlrev_b32 v13, 4, v16
    v_lshl_add_u32 v13, v17, 15, v13
    v_mov_b32 v15, 0
    s_lshl_b32 s46, s40, 2
    s_add_u32 s46, s46, s36
    s_lshl_b32 s60, s46, 17
    s_lshl_b32 s47, s39, 10
    s_add_u32 s60, s60, s47
    s_mul_i32 s47, s46, 205
    s_lshr_b32 s47, s47, 12
    s_mul_i32 s48, s47, 20
    s_sub_u32 s48, s46, s48
    s_mul_i32 s49, s48, 1640
    s_lshr_b32 s49, s49, 10
    s_lshl_b32 s48, s48, 3
    s_add_u32 s48, s48, 12
    s_mul_i32 s48, s48, 205
    s_lshr_b32 s48, s48, 10
    v_and_b32 v20, 3, v0
    v_add_u32 v20, s49, v20
    v_lshrrev_b32 v21, 2, v0
    s_min_u32 s47, s47, 1
    s_lshl_b32 s47, s47, 1
    s_lshr_b32 s49, s39, 1
    v_cmp_gt_u32 vcc, s48, v20
    v_cmp_ge_u32 s[50:51], s47, v21
    v_add_u32 v21, s49, v21
    s_and_b64 s[56:57], vcc, s[50:51]
    v_cmp_gt_u32 vcc, 8, v21
    v_lshl_add_u32 v20, v21, 5, v20
    v_lshlrev_b32 v1, 7, v20
    v_add_u32 v1, 12582912, v1
    s_cmp_lt_u32 s40, 5
    s_cselect_b32 s62, 0x3ea52b5c, 1.0
    s_waitcnt lgkmcnt(0)
    s_and_b64 s[4:5], vcc, s[56:57]
    s_mov_b32 s32, s14
    s_mov_b32 s33, s15
    s_mov_b32 s34, 14680064
    s_mov_b32 s35, 0x20000
    s_cmp_lt_u32 s40, 15
    s_cbranch_scc1 L_p1_go
    s_and_b32 s46, s38, 1
    s_lshl_b32 s46, s46, 3
    s_add_u32 s46, s46, s37
    s_lshl_b32 s46, s46, 2
    s_add_u32 s46, s46, s36
    s_lshl_b32 s46, s46, 11
    s_add_u32 s46, s46, 12582912
    v_lshlrev_b32 v20, 7, v0
    v_mov_b32 v21, 1
    s_mov_b64 exec, 0xffff
    buffer_store_dword v15, v20, s[32:35], s46 offen sc1
    s_mov_b64 exec, 1
    s_waitcnt vmcnt(0)
    global_atomic_add v15, v21, s[12:13] sc1
    s_mov_b64 exec, -1
    s_barrier
    s_mov_b32 s52, 0
    global_load_dword v14, v15, s[12:13] sc1
L_rdy2:
    s_waitcnt vmcnt(0)
    v_readfirstlane_b32 s44, v14
    s_add_u32 s52, s52, 1
    s_cmp_ge_u32 s52, 400000
    s_cbranch_scc1 L_rdy2_ok
    s_cmp_ge_u32 s44, 64
    s_cbranch_scc1 L_rdy2_ok
    global_load_dword v14, v15, s[12:13] sc1
    s_branch L_rdy2
L_rdy2_ok:
    v_mov_b32 v14, 1
    s_branch L_p1_done
L_p1_go:
    s_barrier
    ds_read_b64_tr_b16 v[96:97], v10 offset:0
    ds_read_b64_tr_b16 v[98:99], v10 offset:1024
    ds_read_b128 v[64:67], v2 offset:16384
    ds_read_b128 v[68:71], v2 offset:20480
    ds_read_b64_tr_b16 v[100:101], v10 offset:4096
    ds_read_b64_tr_b16 v[102:103], v10 offset:5120
    ds_read_b128 v[72:75], v3 offset:16384
    ds_read_b128 v[76:79], v3 offset:20480
    ds_read_b64_tr_b16 v[104:105], v10 offset:8192
    ds_read_b64_tr_b16 v[106:107], v10 offset:9216
    ds_read_b128 v[80:83], v4 offset:16384
    ds_read_b128 v[84:87], v4 offset:20480
    s_waitcnt lgkmcnt(8)
    v_mfma_f32_32x32x16_bf16 v[16:31], v[96:99], v[64:67], 0
    v_mfma_f32_32x32x16_bf16 v[32:47], v[96:99], v[68:71], 0
    ds_read_b64_tr_b16 v[108:109], v10 offset:12288
    ds_read_b64_tr_b16 v[110:111], v10 offset:13312
    ds_read_b128 v[64:67], v5 offset:16384
    ds_read_b128 v[68:71], v5 offset:20480
    s_waitcnt lgkmcnt(8)
    v_mfma_f32_32x32x16_bf16 v[16:31], v[100:103], v[72:75], v[16:31]
    v_mfma_f32_32x32x16_bf16 v[32:47], v[100:103], v[76:79], v[32:47]
    s_waitcnt lgkmcnt(4)
    v_mfma_f32_32x32x16_bf16 v[16:31], v[104:107], v[80:83], v[16:31]
    v_mfma_f32_32x32x16_bf16 v[32:47], v[104:107], v[84:87], v[32:47]
    s_waitcnt lgkmcnt(0)
    s_barrier
    ds_read_b64_tr_b16 v[112:113], v10 offset:24576
    ds_read_b64_tr_b16 v[114:115], v10 offset:25600
    ds_read_b128 v[72:75], v2 offset:40960
    ds_read_b128 v[76:79], v2 offset:45056
    ds_read_b64_tr_b16 v[116:117], v10 offset:28672
    ds_read_b64_tr_b16 v[118:119], v10 offset:29696
    ds_read_b128 v[80:83], v3 offset:40960
    ds_read_b128 v[84:87], v3 offset:45056
    v_mfma_f32_32x32x16_bf16 v[16:31], v[108:111], v[64:67], v[16:31]
    v_mfma_f32_32x32x16_bf16 v[32:47], v[108:111], v[68:71], v[32:47]
    ds_read_b64_tr_b16 v[120:121], v10 offset:32768
    ds_read_b64_tr_b16 v[122:123], v10 offset:33792
    ds_read_b128 v[64:67], v4 offset:40960
    ds_read_b128 v[68:71], v4 offset:45056
    s_waitcnt lgkmcnt(8)
    v_mfma_f32_32x32x16_bf16 v[16:31], v[112:115], v[72:75], v[16:31]
    v_mfma_f32_32x32x16_bf16 v[32:47], v[112:115], v[76:79], v[32:47]
    ds_read_b64_tr_b16 v[124:125], v10 offset:36864
    ds_read_b64_tr_b16 v[126:127], v10 offset:37888
    ds_read_b128 v[72:75], v5 offset:40960
    ds_read_b128 v[76:79], v5 offset:45056
    s_waitcnt lgkmcnt(8)
    v_mfma_f32_32x32x16_bf16 v[16:31], v[116:119], v[80:83], v[16:31]
    v_mfma_f32_32x32x16_bf16 v[32:47], v[116:119], v[84:87], v[32:47]
    s_waitcnt lgkmcnt(4)
    v_mfma_f32_32x32x16_bf16 v[16:31], v[120:123], v[64:67], v[16:31]
    v_mfma_f32_32x32x16_bf16 v[32:47], v[120:123], v[68:71], v[32:47]
    s_waitcnt lgkmcnt(0)
    s_barrier
    ds_read_b64_tr_b16 v[128:129], v11 offset:0
    ds_read_b64_tr_b16 v[130:131], v11 offset:1024
    ds_read_b128 v[80:83], v6 offset:16384
    ds_read_b128 v[84:87], v6 offset:20480
    ds_read_b64_tr_b16 v[132:133], v11 offset:4096
    ds_read_b64_tr_b16 v[134:135], v11 offset:5120
    ds_read_b128 v[64:67], v7 offset:16384
    ds_read_b128 v[68:71], v7 offset:20480
    v_mfma_f32_32x32x16_bf16 v[16:31], v[124:127], v[72:75], v[16:31]
    v_mfma_f32_32x32x16_bf16 v[32:47], v[124:127], v[76:79], v[32:47]
    ds_read_b64_tr_b16 v[136:137], v11 offset:8192
    ds_read_b64_tr_b16 v[138:139], v11 offset:9216
    ds_read_b128 v[72:75], v8 offset:16384
    ds_read_b128 v[76:79], v8 offset:20480
    s_waitcnt lgkmcnt(8)
    v_mfma_f32_32x32x16_bf16 v[16:31], v[128:131], v[80:83], v[16:31]
    v_mfma_f32_32x32x16_bf16 v[32:47], v[128:131], v[84:87], v[32:47]
    ds_read_b64_tr_b16 v[140:141], v11 offset:12288
    ds_read_b64_tr_b16 v[142:143], v11 offset:13312
    ds_read_b128 v[80:83], v9 offset:16384
    ds_read_b128 v[84:87], v9 offset:20480
    s_waitcnt lgkmcnt(8)
    v_mfma_f32_32x32x16_bf16 v[16:31], v[132:135], v[64:67], v[16:31]
    v_mfma_f32_32x32x16_bf16 v[32:47], v[132:135], v[68:71], v[32:47]
    s_waitcnt lgkmcnt(4)
    v_mfma_f32_32x32x16_bf16 v[16:31], v[136:139], v[72:75], v[16:31]
    v_mfma_f32_32x32x16_bf16 v[32:47], v[136:139], v[76:79], v[32:47]
    s_waitcnt lgkmcnt(0)
    s_barrier
    ds_read_b64_tr_b16 v[144:145], v11 offset:24576
    ds_read_b64_tr_b16 v[146:147], v11 offset:25600
    ds_read_b128 v[64:67], v6 offset:40960
    ds_read_b128 v[68:71], v6 offset:45056
    ds_read_b64_tr_b16 v[148:149], v11 offset:28672
    ds_read_b64_tr_b16 v[150:151], v11 offset:29696
    ds_read_b128 v[72:75], v7 offset:40960
    ds_read_b128 v[76:79], v7 offset:45056
    v_mfma_f32_32x32x16_bf16 v[16:31], v[140:143], v[80:83], v[16:31]
    v_mfma_f32_32x32x16_bf16 v[32:47], v[140:143], v[84:87], v[32:47]
    ds_read_b64_tr_b16 v[152:153], v11 offset:32768
    ds_read_b64_tr_b16 v[154:155], v11 offset:33792
    ds_read_b128 v[80:83], v8 offset:40960
    ds_read_b128 v[84:87], v8 offset:45056
    s_waitcnt lgkmcnt(8)
    v_mfma_f32_32x32x16_bf16 v[16:31], v[144:147], v[64:67], v[16:31]
    v_mfma_f32_32x32x16_bf16 v[32:47], v[144:147], v[68:71], v[32:47]
    ds_read_b64_tr_b16 v[156:157], v11 offset:36864
    ds_read_b64_tr_b16 v[158:159], v11 offset:37888
    ds_read_b128 v[64:67], v9 offset:40960
    ds_read_b128 v[68:71], v9 offset:45056
    s_waitcnt lgkmcnt(8)
    v_mfma_f32_32x32x16_bf16 v[16:31], v[148:151], v[72:75], v[16:31]
    v_mfma_f32_32x32x16_bf16 v[32:47], v[148:151], v[76:79], v[32:47]
    s_waitcnt lgkmcnt(4)
    v_mfma_f32_32x32x16_bf16 v[16:31], v[152:155], v[80:83], v[16:31]
    v_mfma_f32_32x32x16_bf16 v[32:47], v[152:155], v[84:87], v[32:47]
    s_waitcnt lgkmcnt(0)
    s_barrier
    ds_read_b64_tr_b16 v[160:161], v10 offset:0
    ds_read_b64_tr_b16 v[162:163], v10 offset:1024
    ds_read_b128 v[72:75], v2 offset:16384
    ds_read_b128 v[76:79], v2 offset:20480
    ds_read_b64_tr_b16 v[164:165], v10 offset:4096
    ds_read_b64_tr_b16 v[166:167], v10 offset:5120
    ds_read_b128 v[80:83], v3 offset:16384
    ds_read_b128 v[84:87], v3 offset:20480
    v_mfma_f32_32x32x16_bf16 v[16:31], v[156:159], v[64:67], v[16:31]
    v_mfma_f32_32x32x16_bf16 v[32:47], v[156:159], v[68:71], v[32:47]
    global_load_dword v14, v15, s[12:13] sc1
    ds_read_b64_tr_b16 v[168:169], v10 offset:8192
    ds_read_b64_tr_b16 v[170:171], v10 offset:9216
    ds_read_b128 v[64:67], v4 offset:16384
    ds_read_b128 v[68:71], v4 offset:20480
    s_waitcnt lgkmcnt(8)
    v_mfma_f32_32x32x16_bf16 v[16:31], v[160:163], v[72:75], v[16:31]
    v_mfma_f32_32x32x16_bf16 v[32:47], v[160:163], v[76:79], v[32:47]
    ds_read_b64_tr_b16 v[172:173], v10 offset:12288
    ds_read_b64_tr_b16 v[174:175], v10 offset:13312
    ds_read_b128 v[72:75], v5 offset:16384
    ds_read_b128 v[76:79], v5 offset:20480
    s_waitcnt lgkmcnt(8)
    v_mfma_f32_32x32x16_bf16 v[16:31], v[164:167], v[80:83], v[16:31]
    v_mfma_f32_32x32x16_bf16 v[32:47], v[164:167], v[84:87], v[32:47]
    s_waitcnt lgkmcnt(4)
    v_mfma_f32_32x32x16_bf16 v[16:31], v[168:171], v[64:67], v[16:31]
    v_mfma_f32_32x32x16_bf16 v[32:47], v[168:171], v[68:71], v[32:47]
    s_waitcnt lgkmcnt(0)
    s_barrier
    ds_read_b64_tr_b16 v[176:177], v10 offset:24576
    ds_read_b64_tr_b16 v[178:179], v10 offset:25600
    ds_read_b128 v[80:83], v2 offset:40960
    ds_read_b128 v[84:87], v2 offset:45056
    ds_read_b64_tr_b16 v[180:181], v10 offset:28672
    ds_read_b64_tr_b16 v[182:183], v10 offset:29696
    ds_read_b128 v[64:67], v3 offset:40960
    ds_read_b128 v[68:71], v3 offset:45056
    v_mfma_f32_32x32x16_bf16 v[16:31], v[172:175], v[72:75], v[16:31]
    v_mfma_f32_32x32x16_bf16 v[32:47], v[172:175], v[76:79], v[32:47]
    ds_read_b64_tr_b16 v[184:185], v10 offset:32768
    ds_read_b64_tr_b16 v[186:187], v10 offset:33792
    ds_read_b128 v[72:75], v4 offset:40960
    ds_read_b128 v[76:79], v4 offset:45056
    s_waitcnt lgkmcnt(8)
    v_mfma_f32_32x32x16_bf16 v[16:31], v[176:179], v[80:83], v[16:31]
    v_mfma_f32_32x32x16_bf16 v[32:47], v[176:179], v[84:87], v[32:47]
    ds_read_b64_tr_b16 v[188:189], v10 offset:36864
    ds_read_b64_tr_b16 v[190:191], v10 offset:37888
    ds_read_b128 v[80:83], v5 offset:40960
    ds_read_b128 v[84:87], v5 offset:45056
    s_waitcnt lgkmcnt(8)
    v_mfma_f32_32x32x16_bf16 v[16:31], v[180:183], v[64:67], v[16:31]
    v_mfma_f32_32x32x16_bf16 v[32:47], v[180:183], v[68:71], v[32:47]
    s_waitcnt lgkmcnt(4)
    v_mfma_f32_32x32x16_bf16 v[16:31], v[184:187], v[72:75], v[16:31]
    v_mfma_f32_32x32x16_bf16 v[32:47], v[184:187], v[76:79], v[32:47]
    s_waitcnt lgkmcnt(0)
    s_barrier
    ds_read_b64_tr_b16 v[192:193], v11 offset:0
    ds_read_b64_tr_b16 v[194:195], v11 offset:1024
    ds_read_b128 v[64:67], v6 offset:16384
    ds_read_b128 v[68:71], v6 offset:20480
    ds_read_b64_tr_b16 v[196:197], v11 offset:4096
    ds_read_b64_tr_b16 v[198:199], v11 offset:5120
    ds_read_b128 v[72:75], v7 offset:16384
    ds_read_b128 v[76:79], v7 offset:20480
    v_mfma_f32_32x32x16_bf16 v[16:31], v[188:191], v[80:83], v[16:31]
    v_mfma_f32_32x32x16_bf16 v[32:47], v[188:191], v[84:87], v[32:47]
    ds_read_b64_tr_b16 v[200:201], v11 offset:8192
    ds_read_b64_tr_b16 v[202:203], v11 offset:9216
    ds_read_b128 v[80:83], v8 offset:16384
    ds_read_b128 v[84:87], v8 offset:20480
    s_waitcnt lgkmcnt(8)
    v_mfma_f32_32x32x16_bf16 v[16:31], v[192:195], v[64:67], v[16:31]
    v_mfma_f32_32x32x16_bf16 v[32:47], v[192:195], v[68:71], v[32:47]
    ds_read_b64_tr_b16 v[204:205], v11 offset:12288
    ds_read_b64_tr_b16 v[206:207], v11 offset:13312
    ds_read_b128 v[64:67], v9 offset:16384
    ds_read_b128 v[68:71], v9 offset:20480
    s_waitcnt lgkmcnt(8)
    v_mfma_f32_32x32x16_bf16 v[16:31], v[196:199], v[72:75], v[16:31]
    v_mfma_f32_32x32x16_bf16 v[32:47], v[196:199], v[76:79], v[32:47]
    s_waitcnt lgkmcnt(4)
    v_mfma_f32_32x32x16_bf16 v[16:31], v[200:203], v[80:83], v[16:31]
    v_mfma_f32_32x32x16_bf16 v[32:47], v[200:203], v[84:87], v[32:47]
    s_waitcnt lgkmcnt(0)
    s_barrier
    ds_read_b64_tr_b16 v[208:209], v11 offset:24576
    ds_read_b64_tr_b16 v[210:211], v11 offset:25600
    ds_read_b128 v[72:75], v6 offset:40960
    ds_read_b128 v[76:79], v6 offset:45056
    ds_read_b64_tr_b16 v[212:213], v11 offset:28672
    ds_read_b64_tr_b16 v[214:215], v11 offset:29696
    ds_read_b128 v[80:83], v7 offset:40960
    ds_read_b128 v[84:87], v7 offset:45056
    v_mfma_f32_32x32x16_bf16 v[16:31], v[204:207], v[64:67], v[16:31]
    v_mfma_f32_32x32x16_bf16 v[32:47], v[204:207], v[68:71], v[32:47]
    ds_read_b64_tr_b16 v[216:217], v11 offset:32768
    ds_read_b64_tr_b16 v[218:219], v11 offset:33792
    ds_read_b128 v[64:67], v8 offset:40960
    ds_read_b128 v[68:71], v8 offset:45056
    s_waitcnt lgkmcnt(8)
    v_mfma_f32_32x32x16_bf16 v[16:31], v[208:211], v[72:75], v[16:31]
    v_mfma_f32_32x32x16_bf16 v[32:47], v[208:211], v[76:79], v[32:47]
    ds_read_b64_tr_b16 v[220:221], v11 offset:36864
    ds_read_b64_tr_b16 v[222:223], v11 offset:37888
    ds_read_b128 v[72:75], v9 offset:40960
    ds_read_b128 v[76:79], v9 offset:45056
    s_waitcnt lgkmcnt(8)
    v_mfma_f32_32x32x16_bf16 v[16:31], v[212:215], v[80:83], v[16:31]
    v_mfma_f32_32x32x16_bf16 v[32:47], v[212:215], v[84:87], v[32:47]
    s_waitcnt lgkmcnt(4)
    v_mfma_f32_32x32x16_bf16 v[16:31], v[216:219], v[64:67], v[16:31]
    v_mfma_f32_32x32x16_bf16 v[32:47], v[216:219], v[68:71], v[32:47]
    s_waitcnt lgkmcnt(0)
    s_barrier
    ds_read_b64_tr_b16 v[224:225], v10 offset:0
    ds_read_b64_tr_b16 v[226:227], v10 offset:1024
    ds_read_b128 v[80:83], v2 offset:16384
    ds_read_b128 v[84:87], v2 offset:20480
    ds_read_b64_tr_b16 v[228:229], v10 offset:4096
    ds_read_b64_tr_b16 v[230:231], v10 offset:5120
    ds_read_b128 v[64:67], v3 offset:16384
    ds_read_b128 v[68:71], v3 offset:20480
    v_mfma_f32_32x32x16_bf16 v[16:31], v[220:223], v[72:75], v[16:31]
    v_mfma_f32_32x32x16_bf16 v[32:47], v[220:223], v[76:79], v[32:47]
    s_mov_b32 s52, 0
L_rdy1:
    s_waitcnt vmcnt(0)
    v_readfirstlane_b32 s44, v14
    s_add_u32 s52, s52, 1
    s_cmp_ge_u32 s52, 400000
    s_cbranch_scc1 L_rdy1_ok
    s_cmp_ge_u32 s44, 64
    s_cbranch_scc1 L_rdy1_ok
    global_load_dword v14, v15, s[12:13] sc1
    s_branch L_rdy1
L_rdy1_ok:
    v_mov_b32 v14, 1
    ds_read_b64_tr_b16 v[232:233], v10 offset:8192
    ds_read_b64_tr_b16 v[234:235], v10 offset:9216
    ds_read_b128 v[72:75], v4 offset:16384
    ds_read_b128 v[76:79], v4 offset:20480
    s_waitcnt lgkmcnt(8)
    v_mfma_f32_32x32x16_bf16 v[16:31], v[224:227], v[80:83], v[16:31]
    v_mfma_f32_32x32x16_bf16 v[32:47], v[224:227], v[84:87], v[32:47]
    ds_read_b64_tr_b16 v[236:237], v10 offset:12288
    ds_read_b64_tr_b16 v[238:239], v10 offset:13312
    ds_read_b128 v[80:83], v5 offset:16384
    ds_read_b128 v[84:87], v5 offset:20480
    s_waitcnt lgkmcnt(8)
    v_mfma_f32_32x32x16_bf16 v[16:31], v[228:231], v[64:67], v[16:31]
    v_mfma_f32_32x32x16_bf16 v[32:47], v[228:231], v[68:71], v[32:47]
    s_waitcnt lgkmcnt(4)
    v_mfma_f32_32x32x16_bf16 v[16:31], v[232:235], v[72:75], v[16:31]
    v_mfma_f32_32x32x16_bf16 v[32:47], v[232:235], v[76:79], v[32:47]
    s_waitcnt lgkmcnt(0)
    s_barrier
    ds_read_b64_tr_b16 v[240:241], v10 offset:24576
    ds_read_b64_tr_b16 v[242:243], v10 offset:25600
    ds_read_b128 v[64:67], v2 offset:40960
    ds_read_b128 v[68:71], v2 offset:45056
    ds_read_b64_tr_b16 v[244:245], v10 offset:28672
    ds_read_b64_tr_b16 v[246:247], v10 offset:29696
    ds_read_b128 v[72:75], v3 offset:40960
    ds_read_b128 v[76:79], v3 offset:45056
    v_mfma_f32_32x32x16_bf16 v[16:31], v[236:239], v[80:83], v[16:31]
    v_mfma_f32_32x32x16_bf16 v[32:47], v[236:239], v[84:87], v[32:47]
    ds_read_b64_tr_b16 v[248:249], v10 offset:32768
    ds_read_b64_tr_b16 v[250:251], v10 offset:33792
    ds_read_b128 v[80:83], v4 offset:40960
    ds_read_b128 v[84:87], v4 offset:45056
    s_waitcnt lgkmcnt(8)
    v_mfma_f32_32x32x16_bf16 v[16:31], v[240:243], v[64:67], v[16:31]
    v_mfma_f32_32x32x16_bf16 v[32:47], v[240:243], v[68:71], v[32:47]
    ds_read_b64_tr_b16 v[252:253], v10 offset:36864
    ds_read_b64_tr_b16 v[254:255], v10 offset:37888
    ds_read_b128 v[64:67], v5 offset:40960
    ds_read_b128 v[68:71], v5 offset:45056
    s_waitcnt lgkmcnt(8)
    v_mfma_f32_32x32x16_bf16 v[16:31], v[244:247], v[72:75], v[16:31]
    v_mfma_f32_32x32x16_bf16 v[32:47], v[244:247], v[76:79], v[32:47]
    s_waitcnt lgkmcnt(4)
    v_mfma_f32_32x32x16_bf16 v[16:31], v[248:251], v[80:83], v[16:31]
    v_mfma_f32_32x32x16_bf16 v[32:47], v[248:251], v[84:87], v[32:47]
    s_waitcnt lgkmcnt(0)
    s_barrier
    ds_read_b128 v[72:75], v6 offset:0
    ds_read_b128 v[76:79], v7 offset:0
    ds_read_b128 v[80:83], v8 offset:0
    ds_read_b128 v[84:87], v9 offset:0
    v_mfma_f32_32x32x16_bf16 v[16:31], v[252:255], v[64:67], v[16:31]
    v_mfma_f32_32x32x16_bf16 v[32:47], v[252:255], v[68:71], v[32:47]
    ds_read_b128 v[64:67], v6 offset:4096
    s_waitcnt lgkmcnt(4)
    v_mfma_f32_32x32x16_bf16 v[48:63], v[96:99], v[72:75], 0
    ds_read_b128 v[68:71], v7 offset:4096
    s_waitcnt lgkmcnt(4)
    v_mfma_f32_32x32x16_bf16 v[48:63], v[100:103], v[76:79], v[48:63]
    ds_read_b128 v[72:75], v8 offset:4096
    s_waitcnt lgkmcnt(4)
    v_mfma_f32_32x32x16_bf16 v[48:63], v[104:107], v[80:83], v[48:63]
    ds_read_b128 v[76:79], v9 offset:4096
    s_waitcnt lgkmcnt(4)
    v_mfma_f32_32x32x16_bf16 v[48:63], v[108:111], v[84:87], v[48:63]
    v_mul_f32 v16, s62, v16
    v_mul_f32 v17, s62, v17
    v_mul_f32 v18, s62, v18
    v_mul_f32 v19, s62, v19
    ds_read_b128 v[80:83], v6 offset:8192
    s_waitcnt lgkmcnt(4)
    v_mfma_f32_32x32x16_bf16 v[48:63], v[112:115], v[64:67], v[48:63]
    v_mul_f32 v32, s62, v32
    v_mul_f32 v33, s62, v33
    v_mul_f32 v34, s62, v34
    v_mul_f32 v35, s62, v35
    ds_read_b128 v[84:87], v7 offset:8192
    s_waitcnt lgkmcnt(4)
    v_mfma_f32_32x32x16_bf16 v[48:63], v[116:119], v[68:71], v[48:63]
    v_cvt_pk_bf16_f32 v88, v16, v17
    v_cvt_pk_bf16_f32 v89, v18, v19
    v_cvt_pk_bf16_f32 v90, v32, v33
    v_cvt_pk_bf16_f32 v91, v34, v35
    ds_read_b128 v[64:67], v8 offset:8192
    s_waitcnt lgkmcnt(4)
    v_mfma_f32_32x32x16_bf16 v[48:63], v[120:123], v[72:75], v[48:63]
    s_add_u32 s51, s60, 0
    s_nop 0
    v_permlane32_swap_b32 v88, v90
    v_permlane32_swap_b32 v89, v91
    ds_read_b128 v[68:71], v9 offset:8192
    s_waitcnt lgkmcnt(4)
    v_mfma_f32_32x32x16_bf16 v[48:63], v[124:127], v[76:79], v[48:63]
    buffer_store_dwordx4 v[88:91], v12, s[32:35], s51 offen sc1
    v_mul_f32 v20, s62, v20
    v_mul_f32 v21, s62, v21
    v_mul_f32 v22, s62, v22
    ds_read_b128 v[72:75], v6 offset:12288
    s_waitcnt lgkmcnt(4)
    v_mfma_f32_32x32x16_bf16 v[48:63], v[128:131], v[80:83], v[48:63]
    v_mul_f32 v23, s62, v23
    v_mul_f32 v36, s62, v36
    v_mul_f32 v37, s62, v37
    v_mul_f32 v38, s62, v38
    ds_read_b128 v[76:79], v7 offset:12288
    s_waitcnt lgkmcnt(4)
    v_mfma_f32_32x32x16_bf16 v[48:63], v[132:135], v[84:87], v[48:63]
    v_mul_f32 v39, s62, v39
    v_cvt_pk_bf16_f32 v92, v20, v21
    v_cvt_pk_bf16_f32 v93, v22, v23
    v_cvt_pk_bf16_f32 v94, v36, v37
    ds_read_b128 v[80:83], v8 offset:12288
    s_waitcnt lgkmcnt(4)
    v_mfma_f32_32x32x16_bf16 v[48:63], v[136:139], v[64:67], v[48:63]
    v_cvt_pk_bf16_f32 v95, v38, v39
    s_add_u32 s51, s60, 32768
    s_nop 0
    v_permlane32_swap_b32 v92, v94
    ds_read_b128 v[84:87], v9 offset:12288
    s_waitcnt lgkmcnt(4)
    v_mfma_f32_32x32x16_bf16 v[48:63], v[140:143], v[68:71], v[48:63]
    v_permlane32_swap_b32 v93, v95
    buffer_store_dwordx4 v[92:95], v12, s[32:35], s51 offen sc1
    v_mul_f32 v24, s62, v24
    v_mul_f32 v25, s62, v25
    ds_read_b128 v[64:67], v6 offset:16384
    s_waitcnt lgkmcnt(4)
    v_mfma_f32_32x32x16_bf16 v[48:63], v[144:147], v[72:75], v[48:63]
    v_mul_f32 v26, s62, v26
    v_mul_f32 v27, s62, v27
    v_mul_f32 v40, s62, v40
    v_mul_f32 v41, s62, v41
    ds_read_b128 v[68:71], v7 offset:16384
    s_waitcnt lgkmcnt(4)
    v_mfma_f32_32x32x16_bf16 v[48:63], v[148:151], v[76:79], v[48:63]
    v_mul_f32 v42, s62, v42
    v_mul_f32 v43, s62, v43
    v_cvt_pk_bf16_f32 v88, v24, v25
    v_cvt_pk_bf16_f32 v89, v26, v27
    ds_read_b128 v[72:75], v8 offset:16384
    s_waitcnt lgkmcnt(4)
    v_mfma_f32_32x32x16_bf16 v[48:63], v[152:155], v[80:83], v[48:63]
    v_cvt_pk_bf16_f32 v90, v40, v41
    v_cvt_pk_bf16_f32 v91, v42, v43
    s_add_u32 s51, s60, 65536
    s_nop 0
    ds_read_b128 v[76:79], v9 offset:16384
    s_waitcnt lgkmcnt(4)
    v_mfma_f32_32x32x16_bf16 v[48:63], v[156:159], v[84:87], v[48:63]
    v_permlane32_swap_b32 v88, v90
    v_permlane32_swap_b32 v89, v91
    buffer_store_dwordx4 v[88:91], v12, s[32:35], s51 offen sc1
    v_mul_f32 v28, s62, v28
    s_barrier
    ds_read_b128 v[80:83], v6 offset:24576
    s_waitcnt lgkmcnt(4)
    v_mfma_f32_32x32x16_bf16 v[48:63], v[160:163], v[64:67], v[48:63]
    v_mul_f32 v29, s62, v29
    v_mul_f32 v30, s62, v30
    v_mul_f32 v31, s62, v31
    v_mul_f32 v44, s62, v44
    ds_read_b128 v[84:87], v7 offset:24576
    s_waitcnt lgkmcnt(4)
    v_mfma_f32_32x32x16_bf16 v[48:63], v[164:167], v[68:71], v[48:63]
    v_mul_f32 v45, s62, v45
    v_mul_f32 v46, s62, v46
    v_mul_f32 v47, s62, v47
    v_cvt_pk_bf16_f32 v92, v28, v29
    ds_read_b128 v[64:67], v8 offset:24576
    s_waitcnt lgkmcnt(4)
    v_mfma_f32_32x32x16_bf16 v[48:63], v[168:171], v[72:75], v[48:63]
    v_cvt_pk_bf16_f32 v93, v30, v31
    v_cvt_pk_bf16_f32 v94, v44, v45
    v_cvt_pk_bf16_f32 v95, v46, v47
    s_add_u32 s51, s60, 98304
    ds_read_b128 v[68:71], v9 offset:24576
    s_waitcnt lgkmcnt(4)
    v_mfma_f32_32x32x16_bf16 v[48:63], v[172:175], v[76:79], v[48:63]
    s_nop 0
    v_permlane32_swap_b32 v92, v94
    v_permlane32_swap_b32 v93, v95
    buffer_store_dwordx4 v[92:95], v12, s[32:35], s51 offen sc1
    ds_read_b128 v[72:75], v6 offset:28672
    s_waitcnt lgkmcnt(4)
    v_mfma_f32_32x32x16_bf16 v[48:63], v[176:179], v[80:83], v[48:63]
    ds_read_b128 v[76:79], v7 offset:28672
    s_waitcnt lgkmcnt(4)
    v_mfma_f32_32x32x16_bf16 v[48:63], v[180:183], v[84:87], v[48:63]
    ds_read_b128 v[80:83], v8 offset:28672
    s_waitcnt lgkmcnt(4)
    v_mfma_f32_32x32x16_bf16 v[48:63], v[184:187], v[64:67], v[48:63]
    ds_read_b128 v[84:87], v9 offset:28672
    s_waitcnt lgkmcnt(4)
    v_mfma_f32_32x32x16_bf16 v[48:63], v[188:191], v[68:71], v[48:63]
    ds_read_b128 v[64:67], v6 offset:32768
    s_waitcnt lgkmcnt(4)
    v_mfma_f32_32x32x16_bf16 v[48:63], v[192:195], v[72:75], v[48:63]
    ds_read_b128 v[68:71], v7 offset:32768
    s_waitcnt lgkmcnt(4)
    v_mfma_f32_32x32x16_bf16 v[48:63], v[196:199], v[76:79], v[48:63]
    ds_read_b128 v[72:75], v8 offset:32768
    s_waitcnt lgkmcnt(4)
    v_mfma_f32_32x32x16_bf16 v[48:63], v[200:203], v[80:83], v[48:63]
    ds_read_b128 v[76:79], v9 offset:32768
    s_waitcnt lgkmcnt(4)
    v_mfma_f32_32x32x16_bf16 v[48:63], v[204:207], v[84:87], v[48:63]
    ds_read_b128 v[80:83], v6 offset:36864
    s_waitcnt lgkmcnt(4)
    v_mfma_f32_32x32x16_bf16 v[48:63], v[208:211], v[64:67], v[48:63]
    ds_read_b128 v[84:87], v7 offset:36864
    s_waitcnt lgkmcnt(4)
    v_mfma_f32_32x32x16_bf16 v[48:63], v[212:215], v[68:71], v[48:63]
    ds_read_b128 v[64:67], v8 offset:36864
    s_waitcnt lgkmcnt(4)
    v_mfma_f32_32x32x16_bf16 v[48:63], v[216:219], v[72:75], v[48:63]
    ds_read_b128 v[68:71], v9 offset:36864
    s_waitcnt lgkmcnt(4)
    v_mfma_f32_32x32x16_bf16 v[48:63], v[220:223], v[76:79], v[48:63]
    ds_read_b128 v[72:75], v6 offset:40960
    s_waitcnt lgkmcnt(4)
    v_mfma_f32_32x32x16_bf16 v[48:63], v[224:227], v[80:83], v[48:63]
    ds_read_b128 v[76:79], v7 offset:40960
    s_waitcnt lgkmcnt(4)
    v_mfma_f32_32x32x16_bf16 v[48:63], v[228:231], v[84:87], v[48:63]
    ds_read_b128 v[80:83], v8 offset:40960
    s_waitcnt lgkmcnt(4)
    v_mfma_f32_32x32x16_bf16 v[48:63], v[232:235], v[64:67], v[48:63]
    s_mov_b64 exec, s[56:57]
    s_waitcnt vmcnt(0)
    buffer_atomic_add v14, v1, s[32:35], 0 offen sc1
    s_mov_b64 exec, -1
    ds_read_b128 v[84:87], v9 offset:40960
    s_waitcnt lgkmcnt(4)
    v_mfma_f32_32x32x16_bf16 v[48:63], v[236:239], v[68:71], v[48:63]
    s_barrier
    ds_read_b128 v[64:67], v2 offset:0
    s_waitcnt lgkmcnt(4)
    v_mfma_f32_32x32x16_bf16 v[48:63], v[240:243], v[72:75], v[48:63]
    ds_read_b128 v[68:71], v3 offset:0
    s_waitcnt lgkmcnt(4)
    v_mfma_f32_32x32x16_bf16 v[48:63], v[244:247], v[76:79], v[48:63]
    ds_read_b128 v[72:75], v4 offset:0
    s_waitcnt lgkmcnt(4)
    v_mfma_f32_32x32x16_bf16 v[48:63], v[248:251], v[80:83], v[48:63]
    ds_read_b128 v[76:79], v5 offset:0
    s_waitcnt lgkmcnt(4)
    v_mfma_f32_32x32x16_bf16 v[48:63], v[252:255], v[84:87], v[48:63]
    ds_read_b128 v[80:83], v2 offset:4096
    s_waitcnt lgkmcnt(4)
    v_mfma_f32_32x32x16_bf16 v[16:31], v[96:99], v[64:67], 0
    ds_read_b128 v[84:87], v3 offset:4096
    s_waitcnt lgkmcnt(4)
    v_mfma_f32_32x32x16_bf16 v[16:31], v[100:103], v[68:71], v[16:31]
    ds_read_b128 v[64:67], v4 offset:4096
    s_waitcnt lgkmcnt(4)
    v_mfma_f32_32x32x16_bf16 v[16:31], v[104:107], v[72:75], v[16:31]
    ds_read_b128 v[68:71], v5 offset:4096
    s_waitcnt lgkmcnt(4)
    v_mfma_f32_32x32x16_bf16 v[16:31], v[108:111], v[76:79], v[16:31]
    ds_read_b128 v[72:75], v2 offset:8192
    s_waitcnt lgkmcnt(4)
    v_mfma_f32_32x32x16_bf16 v[16:31], v[112:115], v[80:83], v[16:31]
    v_mul_f32 v48, s62, v48
    v_mul_f32 v49, s62, v49
    v_mul_f32 v50, s62, v50
    v_mul_f32 v51, s62, v51
    ds_read_b128 v[76:79], v3 offset:8192
    s_waitcnt lgkmcnt(4)
    v_mfma_f32_32x32x16_bf16 v[16:31], v[116:119], v[84:87], v[16:31]
    v_mul_f32 v52, s62, v52
    v_mul_f32 v53, s62, v53
    v_mul_f32 v54, s62, v54
    v_mul_f32 v55, s62, v55
    ds_read_b128 v[80:83], v4 offset:8192
    s_waitcnt lgkmcnt(4)
    v_mfma_f32_32x32x16_bf16 v[16:31], v[120:123], v[64:67], v[16:31]
    v_cvt_pk_bf16_f32 v88, v48, v49
    v_cvt_pk_bf16_f32 v89, v50, v51
    v_cvt_pk_bf16_f32 v90, v52, v53
    v_cvt_pk_bf16_f32 v91, v54, v55
    ds_read_b128 v[84:87], v5 offset:8192
    s_waitcnt lgkmcnt(4)
    v_mfma_f32_32x32x16_bf16 v[16:31], v[124:127], v[68:71], v[16:31]
    s_add_u32 s51, s60, 16384
    s_nop 0
    v_permlane32_swap_b32 v88, v90
    v_permlane32_swap_b32 v89, v91
    ds_read_b128 v[64:67], v2 offset:12288
    s_waitcnt lgkmcnt(4)
    v_mfma_f32_32x32x16_bf16 v[16:31], v[128:131], v[72:75], v[16:31]
    buffer_store_dwordx4 v[88:91], v13, s[32:35], s51 offen sc1
    v_mul_f32 v56, s62, v56
    v_mul_f32 v57, s62, v57
    v_mul_f32 v58, s62, v58
    ds_read_b128 v[68:71], v3 offset:12288
    s_waitcnt lgkmcnt(4)
    v_mfma_f32_32x32x16_bf16 v[16:31], v[132:135], v[76:79], v[16:31]
    v_mul_f32 v59, s62, v59
    v_mul_f32 v60, s62, v60
    v_mul_f32 v61, s62, v61
    v_mul_f32 v62, s62, v62
    ds_read_b128 v[72:75], v4 offset:12288
    s_waitcnt lgkmcnt(4)
    v_mfma_f32_32x32x16_bf16 v[16:31], v[136:139], v[80:83], v[16:31]
    v_mul_f32 v63, s62, v63
    v_cvt_pk_bf16_f32 v92, v56, v57
    v_cvt_pk_bf16_f32 v93, v58, v59
    v_cvt_pk_bf16_f32 v94, v60, v61
    ds_read_b128 v[76:79], v5 offset:12288
    s_waitcnt lgkmcnt(4)
    v_mfma_f32_32x32x16_bf16 v[16:31], v[140:143], v[84:87], v[16:31]
    v_cvt_pk_bf16_f32 v95, v62, v63
    s_add_u32 s51, s60, 81920
    s_nop 0
    v_permlane32_swap_b32 v92, v94
    ds_read_b128 v[80:83], v2 offset:16384
    s_waitcnt lgkmcnt(4)
    v_mfma_f32_32x32x16_bf16 v[16:31], v[144:147], v[64:67], v[16:31]
    v_permlane32_swap_b32 v93, v95
    buffer_store_dwordx4 v[92:95], v13, s[32:35], s51 offen sc1
    ds_read_b128 v[84:87], v3 offset:16384
    s_waitcnt lgkmcnt(4)
    v_mfma_f32_32x32x16_bf16 v[16:31], v[148:151], v[68:71], v[16:31]
    ds_read_b128 v[64:67], v4 offset:16384
    s_waitcnt lgkmcnt(4)
    v_mfma_f32_32x32x16_bf16 v[16:31], v[152:155], v[72:75], v[16:31]
    ds_read_b128 v[68:71], v5 offset:16384
    s_waitcnt lgkmcnt(4)
    v_mfma_f32_32x32x16_bf16 v[16:31], v[156:159], v[76:79], v[16:31]
    ds_read_b128 v[72:75], v2 offset:24576
    s_waitcnt lgkmcnt(4)
    v_mfma_f32_32x32x16_bf16 v[16:31], v[160:163], v[80:83], v[16:31]
    ds_read_b128 v[76:79], v3 offset:24576
    s_waitcnt lgkmcnt(4)
    v_mfma_f32_32x32x16_bf16 v[16:31], v[164:167], v[84:87], v[16:31]
    ds_read_b128 v[80:83], v4 offset:24576
    s_waitcnt lgkmcnt(4)
    v_mfma_f32_32x32x16_bf16 v[16:31], v[168:171], v[64:67], v[16:31]
    ds_read_b128 v[84:87], v5 offset:24576
    s_waitcnt lgkmcnt(4)
    v_mfma_f32_32x32x16_bf16 v[16:31], v[172:175], v[68:71], v[16:31]
    ds_read_b128 v[64:67], v2 offset:28672
    s_waitcnt lgkmcnt(4)
    v_mfma_f32_32x32x16_bf16 v[16:31], v[176:179], v[72:75], v[16:31]
    ds_read_b128 v[68:71], v3 offset:28672
    s_waitcnt lgkmcnt(4)
    v_mfma_f32_32x32x16_bf16 v[16:31], v[180:183], v[76:79], v[16:31]
    ds_read_b128 v[72:75], v4 offset:28672
    s_waitcnt lgkmcnt(4)
    v_mfma_f32_32x32x16_bf16 v[16:31], v[184:187], v[80:83], v[16:31]
    ds_read_b128 v[76:79], v5 offset:28672
    s_waitcnt lgkmcnt(4)
    v_mfma_f32_32x32x16_bf16 v[16:31], v[188:191], v[84:87], v[16:31]
    ds_read_b128 v[80:83], v2 offset:32768
    s_waitcnt lgkmcnt(4)
    v_mfma_f32_32x32x16_bf16 v[16:31], v[192:195], v[64:67], v[16:31]
    ds_read_b128 v[84:87], v3 offset:32768
    s_waitcnt lgkmcnt(4)
    v_mfma_f32_32x32x16_bf16 v[16:31], v[196:199], v[68:71], v[16:31]
    ds_read_b128 v[64:67], v4 offset:32768
    s_waitcnt lgkmcnt(4)
    v_mfma_f32_32x32x16_bf16 v[16:31], v[200:203], v[72:75], v[16:31]
    ds_read_b128 v[68:71], v5 offset:32768
    s_waitcnt lgkmcnt(4)
    v_mfma_f32_32x32x16_bf16 v[16:31], v[204:207], v[76:79], v[16:31]
    ds_read_b128 v[72:75], v2 offset:36864
    s_waitcnt lgkmcnt(4)
    v_mfma_f32_32x32x16_bf16 v[16:31], v[208:211], v[80:83], v[16:31]
    ds_read_b128 v[76:79], v3 offset:36864
    s_waitcnt lgkmcnt(4)
    v_mfma_f32_32x32x16_bf16 v[16:31], v[212:215], v[84:87], v[16:31]
    ds_read_b128 v[80:83], v4 offset:36864
    s_waitcnt lgkmcnt(4)
    v_mfma_f32_32x32x16_bf16 v[16:31], v[216:219], v[64:67], v[16:31]
    ds_read_b128 v[84:87], v5 offset:36864
    s_waitcnt lgkmcnt(4)
    v_mfma_f32_32x32x16_bf16 v[16:31], v[220:223], v[68:71], v[16:31]
    ds_read_b128 v[64:67], v2 offset:40960
    s_waitcnt lgkmcnt(4)
    v_mfma_f32_32x32x16_bf16 v[16:31], v[224:227], v[72:75], v[16:31]
    ds_read_b128 v[68:71], v3 offset:40960
    s_waitcnt lgkmcnt(4)
    v_mfma_f32_32x32x16_bf16 v[16:31], v[228:231], v[76:79], v[16:31]
    ds_read_b128 v[72:75], v4 offset:40960
    s_waitcnt lgkmcnt(4)
    v_mfma_f32_32x32x16_bf16 v[16:31], v[232:235], v[80:83], v[16:31]
    ds_read_b128 v[76:79], v5 offset:40960
    s_waitcnt lgkmcnt(4)
    v_mfma_f32_32x32x16_bf16 v[16:31], v[236:239], v[84:87], v[16:31]
    s_waitcnt lgkmcnt(3)
    v_mfma_f32_32x32x16_bf16 v[16:31], v[240:243], v[64:67], v[16:31]
    s_waitcnt lgkmcnt(2)
    v_mfma_f32_32x32x16_bf16 v[16:31], v[244:247], v[68:71], v[16:31]
    s_waitcnt lgkmcnt(1)
    v_mfma_f32_32x32x16_bf16 v[16:31], v[248:251], v[72:75], v[16:31]
    s_waitcnt lgkmcnt(0)
    v_mfma_f32_32x32x16_bf16 v[16:31], v[252:255], v[76:79], v[16:31]
    v_mov_b32 v64, 163328
    s_mov_b64 exec, 1
    ds_add_u32 v64, v14 offset:8
    s_mov_b64 exec, -1
    s_mov_b32 s50, 32768
    s_nop 6
    v_mul_f32 v16, s62, v16
    v_mul_f32 v17, s62, v17
    v_mul_f32 v18, s62, v18
    v_mul_f32 v19, s62, v19
    v_mul_f32 v20, s62, v20
    v_mul_f32 v21, s62, v21
    v_mul_f32 v22, s62, v22
    v_mul_f32 v23, s62, v23
    v_cvt_pk_bf16_f32 v88, v16, v17
    v_cvt_pk_bf16_f32 v89, v18, v19
    v_cvt_pk_bf16_f32 v90, v20, v21
    v_cvt_pk_bf16_f32 v91, v22, v23
    s_add_u32 s51, s60, 16896
    s_nop 0
    v_permlane32_swap_b32 v88, v90
    v_permlane32_swap_b32 v89, v91
    buffer_store_dwordx4 v[88:91], v13, s[32:35], s51 offen sc1
    v_mul_f32 v24, s62, v24
    v_mul_f32 v25, s62, v25
    v_mul_f32 v26, s62, v26
    v_mul_f32 v27, s62, v27
    v_mul_f32 v28, s62, v28
    v_mul_f32 v29, s62, v29
    v_mul_f32 v30, s62, v30
    v_mul_f32 v31, s62, v31
    v_cvt_pk_bf16_f32 v92, v24, v25
    v_cvt_pk_bf16_f32 v93, v26, v27
    v_cvt_pk_bf16_f32 v94, v28, v29
    v_cvt_pk_bf16_f32 v95, v30, v31
    s_add_u32 s51, s60, 82432
    s_nop 0
    v_permlane32_swap_b32 v92, v94
    v_permlane32_swap_b32 v93, v95
    buffer_store_dwordx4 v[92:95], v13, s[32:35], s51 offen sc1
L_p1_done:
L_prep:
    v_and_b32 v25, 31, v0
    v_lshrrev_b32 v26, 5, v0
    v_lshlrev_b32 v27, 2, v26
    v_sub_u32 v27, v27, v25
    v_add_u32 v32, -1, v27
    v_ashrrev_i32 v32, 31, v32
    v_add_u32 v33, 0, v27
    v_ashrrev_i32 v33, 31, v33
    v_add_u32 v34, 1, v27
    v_ashrrev_i32 v34, 31, v34
    v_add_u32 v35, 2, v27
    v_ashrrev_i32 v35, 31, v35
    v_add_u32 v36, 7, v27
    v_ashrrev_i32 v36, 31, v36
    v_add_u32 v37, 8, v27
    v_ashrrev_i32 v37, 31, v37
    v_add_u32 v38, 9, v27
    v_ashrrev_i32 v38, 31, v38
    v_add_u32 v39, 10, v27
    v_ashrrev_i32 v39, 31, v39
    v_add_u32 v40, 15, v27
    v_ashrrev_i32 v40, 31, v40
    v_add_u32 v41, 16, v27
    v_ashrrev_i32 v41, 31, v41
    v_add_u32 v42, 17, v27
    v_ashrrev_i32 v42, 31, v42
    v_add_u32 v43, 18, v27
    v_ashrrev_i32 v43, 31, v43
    v_add_u32 v44, 23, v27
    v_ashrrev_i32 v44, 31, v44
    v_add_u32 v45, 24, v27
    v_ashrrev_i32 v45, 31, v45
    v_add_u32 v46, 25, v27
    v_ashrrev_i32 v46, 31, v46
    v_add_u32 v47, 26, v27
    v_ashrrev_i32 v47, 31, v47
    s_mov_b32 s47, 0xffff
    v_bfi_b32 v48, s47, v32, v33
    v_bfi_b32 v49, s47, v34, v35
    v_bfi_b32 v50, s47, v36, v37
    v_bfi_b32 v51, s47, v38, v39
    v_bfi_b32 v52, s47, v40, v41
    v_bfi_b32 v53, s47, v42, v43
    v_bfi_b32 v54, s47, v44, v45
    v_bfi_b32 v55, s47, v46, v47
    s_cmp_eq_u32 s61, 1
    s_cbranch_scc1 L_nof
    s_cmp_ge_u32 s40, 15
    s_cbranch_scc1 L_nof
    s_mov_b64 exec, s[4:5]
    s_waitcnt vmcnt(0)
    buffer_atomic_add v14, v1, s[32:35], s50 offen sc1
    s_mov_b64 exec, -1
L_nof:
    s_and_b32 s101, s36, 3
    s_lshl_b32 s62, s101, 10
    s_lshl_b32 s46, s101, 6
    v_add_u32 v28, s46, v0
    s_mul_i32 s60, s42, 160
    v_mov_b32 v9, 163328
    v_mul_u32_u24 v27, 6554, v28
    v_lshrrev_b32 v27, 16, v27
    v_mul_u32_u24 v30, 10, v27
    v_sub_u32 v30, v28, v30
    v_and_b32 v31, 0x63, v27
    v_bfe_u32 v29, v27, 2, 2
    v_lshl_add_u32 v31, v29, 3, v31
    v_bfe_u32 v29, v27, 4, 1
    v_lshl_add_u32 v31, v29, 2, v31
    v_mul_u32_u24 v31, 1280, v31
    v_lshl_add_u32 v230, v30, 4, v31
    v_add_u32 v28, 256, v28
    v_mul_u32_u24 v27, 6554, v28
    v_lshrrev_b32 v27, 16, v27
    v_mul_u32_u24 v30, 10, v27
    v_sub_u32 v30, v28, v30
    v_and_b32 v31, 0x63, v27
    v_bfe_u32 v29, v27, 2, 2
    v_lshl_add_u32 v31, v29, 3, v31
    v_bfe_u32 v29, v27, 4, 1
    v_lshl_add_u32 v31, v29, 2, v31
    v_mul_u32_u24 v31, 1280, v31
    v_lshl_add_u32 v231, v30, 4, v31
    v_add_u32 v28, 256, v28
    v_mul_u32_u24 v27, 6554, v28
    v_lshrrev_b32 v27, 16, v27
    v_mul_u32_u24 v30, 10, v27
    v_sub_u32 v30, v28, v30
    v_and_b32 v31, 0x63, v27
    v_bfe_u32 v29, v27, 2, 2
    v_lshl_add_u32 v31, v29, 3, v31
    v_bfe_u32 v29, v27, 4, 1
    v_lshl_add_u32 v31, v29, 2, v31
    v_mul_u32_u24 v31, 1280, v31
    v_lshl_add_u32 v232, v30, 4, v31
    v_add_u32 v28, 256, v28
    v_mul_u32_u24 v27, 6554, v28
    v_lshrrev_b32 v27, 16, v27
    v_mul_u32_u24 v30, 10, v27
    v_sub_u32 v30, v28, v30
    v_and_b32 v31, 0x63, v27
    v_bfe_u32 v29, v27, 2, 2
    v_lshl_add_u32 v31, v29, 3, v31
    v_bfe_u32 v29, v27, 4, 1
    v_lshl_add_u32 v31, v29, 2, v31
    v_mul_u32_u24 v31, 1280, v31
    v_lshl_add_u32 v233, v30, 4, v31
    v_add_u32 v28, 256, v28
    v_mul_u32_u24 v27, 6554, v28
    v_lshrrev_b32 v27, 16, v27
    v_mul_u32_u24 v30, 10, v27
    v_sub_u32 v30, v28, v30
    v_and_b32 v31, 0x63, v27
    v_bfe_u32 v29, v27, 2, 2
    v_lshl_add_u32 v31, v29, 3, v31
    v_bfe_u32 v29, v27, 4, 1
    v_lshl_add_u32 v31, v29, 2, v31
    v_mul_u32_u24 v31, 1280, v31
    v_lshl_add_u32 v234, v30, 4, v31
    s_mov_b32 s24, s8
    s_mov_b32 s25, s9
    s_mov_b32 s26, 819200
    s_mov_b32 s27, 0x20000
    s_cmp_eq_u32 s61, 1
    s_cbranch_scc1 L_nowo0
    s_cmp_ge_u32 s40, 15
    s_cbranch_scc1 L_wo0
L_wp1:
    ds_read_b32 v27, v9 offset:8
    s_waitcnt lgkmcnt(0)
    v_cmp_gt_u32 vcc, 4, v27
    s_cbranch_vccnz L_wp1
L_wo0:
L_nowo0:
    s_xor_b32 s46, s61, 1
    s_lshl_b32 s46, s46, 3
    s_add_u32 s3, s42, s46
    s_mul_i32 s100, s61, 120320
    s_lshl_b32 s46, s101, 9
    s_add_u32 s46, s46, s100
    v_lshlrev_b32 v27, 4, v25
    v_add_u32 v28, s46, v27
    v_mul_u32_u24 v29, 6144, v26
    v_add_u32 v2, v28, v29
    s_lshl_b32 s47, s43, 3
    s_add_u32 s48, s47, 12288
    v_add_u32 v3, s48, v28
    s_sub_u32 s48, 12488, s47
    s_add_u32 s48, s48, s100
    v_mov_b32 v31, s48
    v_cndmask_b32 v3, v3, v31, s[54:55]
    v_lshl_add_u32 v8, v0, 8, v31
    v_lshl_add_u32 v10, v26, 11, v28
    v_add_u32 v10, 36864, v10
    s_add_u32 s48, s47, 40960
    v_add_u32 v11, s48, v28
    s_lshr_b32 s47, s41, 1
    s_mul_i32 s59, s47, 5
    s_mul_i32 s48, s43, 3
    s_add_u32 s48, s48, s59
    s_lshl_b32 s48, s48, 15
    s_add_u32 s50, s59, 2
    s_lshl_b32 s50, s50, 15
    s_lshl_b32 s49, s3, 11
    s_add_u32 s48, s48, s49
    s_add_u32 s50, s50, s49
    v_lshlrev_b32 v30, 4, v0
    v_add_u32 v224, s48, v30
    v_add_u32 v225, 32768, v224
    v_add_u32 v226, s50, v30
    v_xor_b32 v227, 64, v225
    v_xor_b32 v228, 128, v226
    s_lshl_b32 s49, s101, 9
    s_add_u32 s49, s49, 8388608
    s_add_u32 s48, s48, s49
    v_lshl_add_u32 v6, v26, 15, v27
    v_add_u32 v6, s48, v6
    s_add_u32 s50, s50, s49
    s_lshl_b32 s51, s43, 3
    s_add_u32 s50, s50, s51
    v_add_u32 v7, s50, v27
    s_cmp_eq_u32 s61, 0
    s_cbranch_scc1 L_nopreo
    v_lshl_add_u32 v28, v26, 14, v7
    buffer_load_dword v252, v28, s[32:35], 0 offen sc1
L_nopreo:
    v_bfe_u32 v30, v0, 4, 1
    v_bfe_u32 v29, v0, 1, 1
    v_cmp_eq_u32 vcc, 1, v30
    v_mov_b32 v28, 2
    v_and_b32 v25, 1, v0
    v_cndmask_b32 v29, v29, v28, vcc
    v_and_b32 v30, v25, v30
    v_mov_b32 v28, s43
    v_cndmask_b32 v25, v25, v28, vcc
    v_bfe_u32 v28, v0, 2, 2
    v_lshl_add_u32 v28, v26, 2, v28
    v_lshlrev_b32 v26, 2, v29
    v_mul_u32_u24 v27, 6144, v29
    v_lshl_add_u32 v27, v25, 3, v27
    s_add_u32 s46, s46, 18432
    v_add_u32 v27, s46, v27
    v_xor_b32 v25, v28, v26
    v_lshl_add_u32 v4, v25, 4, v27
    v_or_b32 v28, 8, v28
    v_xor_b32 v25, v28, v26
    v_lshl_add_u32 v5, v25, 4, v27
    v_cmp_eq_u32 vcc, 1, v30
    s_lshl_b32 s47, s3, 2
    s_add_u32 s47, s47, s101
    v_cndmask_b32 v4, v4, v31, vcc
    v_cndmask_b32 v5, v5, v31, vcc
    s_min_u32 s58, s47, 7
    s_lshr_b32 s63, s47, 3
    v_mov_b32 v22, 0x3f80
    v_mov_b32 v23, 0
    v_mov_b32 v221, 0
    s_lshl_b32 s47, s43, 1
    s_add_u32 s47, s47, s59
    s_add_u32 s48, s47, 2
    s_lshr_b32 s47, s47, 2
    s_lshr_b32 s48, s48, 2
    s_sub_u32 s48, s48, s47
    s_movk_i32 s98, 0x3fff
    s_cmp_eq_u32 s3, 1
    s_cselect_b32 s98, 0x3cf3, s98
    s_cmp_eq_u32 s3, 0
    s_cselect_b32 s98, 0x30c3, s98
    s_bcnt1_i32_b32 s99, s98
    s_lshl_b32 s99, s99, s48
    s_lshl_b32 s47, 0x1111, s101
    s_and_b32 s98, s98, s47
    s_lshl_b32 s46, s3, 5
    s_add_u32 s46, s46, s41
    s_lshl_b32 s46, s46, 7
    s_add_u32 s46, s46, 12582912
    v_mov_b32 v222, s46
    s_cmp_eq_u32 s61, 0
    s_cbranch_scc1 L_fetch
    s_mov_b64 exec, 0xffff
    v_lshl_add_u32 v25, v0, 2, v9
    ds_write_b32 v25, v221
    s_mov_b64 exec, -1
    s_waitcnt lgkmcnt(0)
    s_cmp_ge_u32 s40, 15
    s_cbranch_scc1 L_ld_idle2
    s_mov_b32 s16, s4
    s_mov_b32 s17, s5
    s_mov_b32 s18, 2621440
    s_mov_b32 s19, 0x20000
    s_mov_b32 s20, s6
    s_mov_b32 s21, s7
    s_mov_b32 s22, 2457600
    s_mov_b32 s23, 0x20000
    s_waitcnt vmcnt(12)
    s_barrier
    s_mul_i32 s97, s96, 245760
    s_add_u32 m0, s45, 73728
    s_add_u32 s51, s97, 0
    buffer_load_dwordx4 v241, s[20:23], s51 offen lds
    s_add_u32 m0, s45, 77824
    s_add_u32 s51, s97, 61440
    buffer_load_dwordx4 v241, s[20:23], s51 offen lds
    s_add_u32 m0, s45, 81920
    s_add_u32 s51, s97, 122880
    buffer_load_dwordx4 v241, s[20:23], s51 offen lds
    s_add_u32 m0, s45, 86016
    s_add_u32 s51, s97, 184320
    buffer_load_dwordx4 v241, s[20:23], s51 offen lds
    s_lshl_b32 s97, s96, 7
    s_add_u32 m0, s45, 90112
    s_add_u32 s51, s97, 0
    buffer_load_dwordx4 v240, s[16:19], s51 offen lds
    s_add_u32 m0, s45, 94208
    s_add_u32 s51, s97, 40960
    buffer_load_dwordx4 v240, s[16:19], s51 offen lds
    s_add_u32 s96, s96, 1
    s_cmp_ge_u32 s96, 10
    s_cselect_b32 s96, 0, s96
    s_waitcnt vmcnt(12)
    s_barrier
    s_mul_i32 s97, s96, 245760
    s_add_u32 m0, s45, 0
    s_add_u32 s51, s97, 0
    buffer_load_dwordx4 v241, s[20:23], s51 offen lds
    s_add_u32 m0, s45, 4096
    s_add_u32 s51, s97, 61440
    buffer_load_dwordx4 v241, s[20:23], s51 offen lds
    s_add_u32 m0, s45, 8192
    s_add_u32 s51, s97, 122880
    buffer_load_dwordx4 v241, s[20:23], s51 offen lds
    s_add_u32 m0, s45, 12288
    s_add_u32 s51, s97, 184320
    buffer_load_dwordx4 v241, s[20:23], s51 offen lds
    s_lshl_b32 s97, s96, 7
    s_add_u32 m0, s45, 16384
    s_add_u32 s51, s97, 0
    buffer_load_dwordx4 v240, s[16:19], s51 offen lds
    s_add_u32 m0, s45, 20480
    s_add_u32 s51, s97, 40960
    buffer_load_dwordx4 v240, s[16:19], s51 offen lds
    s_add_u32 s96, s96, 1
    s_cmp_ge_u32 s96, 10
    s_cselect_b32 s96, 0, s96
    s_waitcnt vmcnt(12)
    s_barrier
    s_mul_i32 s97, s96, 245760
    s_add_u32 m0, s45, 24576
    s_add_u32 s51, s97, 0
    buffer_load_dwordx4 v241, s[20:23], s51 offen lds
    s_add_u32 m0, s45, 28672
    s_add_u32 s51, s97, 61440
    buffer_load_dwordx4 v241, s[20:23], s51 offen lds
    s_add_u32 m0, s45, 32768
    s_add_u32 s51, s97, 122880
    buffer_load_dwordx4 v241, s[20:23], s51 offen lds
    s_add_u32 m0, s45, 36864
    s_add_u32 s51, s97, 184320
    buffer_load_dwordx4 v241, s[20:23], s51 offen lds
    s_lshl_b32 s97, s96, 7
    s_add_u32 m0, s45, 40960
    s_add_u32 s51, s97, 0
    buffer_load_dwordx4 v240, s[16:19], s51 offen lds
    s_add_u32 m0, s45, 45056
    s_add_u32 s51, s97, 40960
    buffer_load_dwordx4 v240, s[16:19], s51 offen lds
    s_add_u32 s96, s96, 1
    s_cmp_ge_u32 s96, 10
    s_cselect_b32 s96, 0, s96
    s_waitcnt vmcnt(12)
    s_barrier
    s_mul_i32 s97, s96, 245760
    s_add_u32 m0, s45, 49152
    s_add_u32 s51, s97, 0
    buffer_load_dwordx4 v241, s[20:23], s51 offen lds
    s_add_u32 m0, s45, 53248
    s_add_u32 s51, s97, 61440
    buffer_load_dwordx4 v241, s[20:23], s51 offen lds
    s_add_u32 m0, s45, 57344
    s_add_u32 s51, s97, 122880
    buffer_load_dwordx4 v241, s[20:23], s51 offen lds
    s_add_u32 m0, s45, 61440
    s_add_u32 s51, s97, 184320
    buffer_load_dwordx4 v241, s[20:23], s51 offen lds
    s_lshl_b32 s97, s96, 7
    s_add_u32 m0, s45, 65536
    s_add_u32 s51, s97, 0
    buffer_load_dwordx4 v240, s[16:19], s51 offen lds
    s_add_u32 m0, s45, 69632
    s_add_u32 s51, s97, 40960
    buffer_load_dwordx4 v240, s[16:19], s51 offen lds
    s_add_u32 s96, s96, 1
    s_cmp_ge_u32 s96, 10
    s_cselect_b32 s96, 0, s96
    s_waitcnt vmcnt(12)
    s_barrier
    s_mul_i32 s97, s96, 245760
    s_add_u32 m0, s45, 73728
    s_add_u32 s51, s97, 0
    buffer_load_dwordx4 v241, s[20:23], s51 offen lds
    s_add_u32 m0, s45, 77824
    s_add_u32 s51, s97, 61440
    buffer_load_dwordx4 v241, s[20:23], s51 offen lds
    s_add_u32 m0, s45, 81920
    s_add_u32 s51, s97, 122880
    buffer_load_dwordx4 v241, s[20:23], s51 offen lds
    s_add_u32 m0, s45, 86016
    s_add_u32 s51, s97, 184320
    buffer_load_dwordx4 v241, s[20:23], s51 offen lds
    s_lshl_b32 s97, s96, 7
    s_add_u32 m0, s45, 90112
    s_add_u32 s51, s97, 0
    buffer_load_dwordx4 v240, s[16:19], s51 offen lds
    s_add_u32 m0, s45, 94208
    s_add_u32 s51, s97, 40960
    buffer_load_dwordx4 v240, s[16:19], s51 offen lds
    s_add_u32 s96, s96, 1
    s_cmp_ge_u32 s96, 10
    s_cselect_b32 s96, 0, s96
    s_waitcnt vmcnt(12)
    s_barrier
    s_mul_i32 s97, s96, 245760
    s_add_u32 m0, s45, 0
    s_add_u32 s51, s97, 0
    buffer_load_dwordx4 v241, s[20:23], s51 offen lds
    s_add_u32 m0, s45, 4096
    s_add_u32 s51, s97, 61440
    buffer_load_dwordx4 v241, s[20:23], s51 offen lds
    s_add_u32 m0, s45, 8192
    s_add_u32 s51, s97, 122880
    buffer_load_dwordx4 v241, s[20:23], s51 offen lds
    s_add_u32 m0, s45, 12288
    s_add_u32 s51, s97, 184320
    buffer_load_dwordx4 v241, s[20:23], s51 offen lds
    s_lshl_b32 s97, s96, 7
    s_add_u32 m0, s45, 16384
    s_add_u32 s51, s97, 0
    buffer_load_dwordx4 v240, s[16:19], s51 offen lds
    s_add_u32 m0, s45, 20480
    s_add_u32 s51, s97, 40960
    buffer_load_dwordx4 v240, s[16:19], s51 offen lds
    s_add_u32 s96, s96, 1
    s_cmp_ge_u32 s96, 10
    s_cselect_b32 s96, 0, s96
    s_waitcnt vmcnt(12)
    s_barrier
    s_mul_i32 s97, s96, 245760
    s_add_u32 m0, s45, 24576
    s_add_u32 s51, s97, 0
    buffer_load_dwordx4 v241, s[20:23], s51 offen lds
    s_add_u32 m0, s45, 28672
    s_add_u32 s51, s97, 61440
    buffer_load_dwordx4 v241, s[20:23], s51 offen lds
    s_add_u32 m0, s45, 32768
    s_add_u32 s51, s97, 122880
    buffer_load_dwordx4 v241, s[20:23], s51 offen lds
    s_add_u32 m0, s45, 36864
    s_add_u32 s51, s97, 184320
    buffer_load_dwordx4 v241, s[20:23], s51 offen lds
    s_lshl_b32 s97, s96, 7
    s_add_u32 m0, s45, 40960
    s_add_u32 s51, s97, 0
    buffer_load_dwordx4 v240, s[16:19], s51 offen lds
    s_add_u32 m0, s45, 45056
    s_add_u32 s51, s97, 40960
    buffer_load_dwordx4 v240, s[16:19], s51 offen lds
    s_add_u32 s96, s96, 1
    s_cmp_ge_u32 s96, 10
    s_cselect_b32 s96, 0, s96
    s_waitcnt vmcnt(12)
    s_barrier
    s_lshl_b32 s97, s96, 7
    s_add_u32 m0, s45, 49152
    s_add_u32 s51, s97, 1310720
    buffer_load_dwordx4 v240, s[16:19], s51 offen lds
    s_add_u32 s96, s96, 1
    s_cmp_ge_u32 s96, 10
    s_cselect_b32 s96, 0, s96
    s_lshl_b32 s97, s96, 7
    s_add_u32 m0, s45, 53248
    s_add_u32 s51, s97, 1310720
    buffer_load_dwordx4 v240, s[16:19], s51 offen lds
    s_add_u32 s96, s96, 1
    s_cmp_ge_u32 s96, 10
    s_cselect_b32 s96, 0, s96
    s_lshl_b32 s97, s96, 7
    s_add_u32 m0, s45, 57344
    s_add_u32 s51, s97, 1310720
    buffer_load_dwordx4 v240, s[16:19], s51 offen lds
    s_add_u32 s96, s96, 1
    s_cmp_ge_u32 s96, 10
    s_cselect_b32 s96, 0, s96
    s_lshl_b32 s97, s96, 7
    s_add_u32 m0, s45, 61440
    s_add_u32 s51, s97, 1310720
    buffer_load_dwordx4 v240, s[16:19], s51 offen lds
    s_add_u32 s96, s96, 1
    s_cmp_ge_u32 s96, 10
    s_cselect_b32 s96, 0, s96
    s_lshl_b32 s97, s96, 7
    s_add_u32 m0, s45, 65536
    s_add_u32 s51, s97, 1310720
    buffer_load_dwordx4 v240, s[16:19], s51 offen lds
    s_add_u32 s96, s96, 1
    s_cmp_ge_u32 s96, 10
    s_cselect_b32 s96, 0, s96
    s_waitcnt vmcnt(11)
    s_barrier
    global_load_dword v220, v221, s[12:13] sc1
    s_lshl_b32 s97, s96, 7
    s_add_u32 m0, s45, 73728
    s_add_u32 s51, s97, 1310720
    buffer_load_dwordx4 v240, s[16:19], s51 offen lds
    s_add_u32 s96, s96, 1
    s_cmp_ge_u32 s96, 10
    s_cselect_b32 s96, 0, s96
    s_lshl_b32 s97, s96, 7
    s_add_u32 m0, s45, 77824
    s_add_u32 s51, s97, 1310720
    buffer_load_dwordx4 v240, s[16:19], s51 offen lds
    s_add_u32 s96, s96, 1
    s_cmp_ge_u32 s96, 10
    s_cselect_b32 s96, 0, s96
    s_lshl_b32 s97, s96, 7
    s_add_u32 m0, s45, 81920
    s_add_u32 s51, s97, 1310720
    buffer_load_dwordx4 v240, s[16:19], s51 offen lds
    s_add_u32 s96, s96, 1
    s_cmp_ge_u32 s96, 10
    s_cselect_b32 s96, 0, s96
    s_lshl_b32 s97, s96, 7
    s_add_u32 m0, s45, 86016
    s_add_u32 s51, s97, 1310720
    buffer_load_dwordx4 v240, s[16:19], s51 offen lds
    s_add_u32 s96, s96, 1
    s_cmp_ge_u32 s96, 10
    s_cselect_b32 s96, 0, s96
    s_lshl_b32 s97, s96, 7
    s_add_u32 m0, s45, 90112
    s_add_u32 s51, s97, 1310720
    buffer_load_dwordx4 v240, s[16:19], s51 offen lds
    s_add_u32 s96, s96, 1
    s_cmp_ge_u32 s96, 10
    s_cselect_b32 s96, 0, s96
    s_waitcnt vmcnt(10)
    s_barrier
    s_lshl_b32 s97, s96, 7
    s_add_u32 m0, s45, 0
    s_add_u32 s51, s97, 1351680
    buffer_load_dwordx4 v240, s[16:19], s51 offen lds
    s_add_u32 s96, s96, 1
    s_cmp_ge_u32 s96, 10
    s_cselect_b32 s96, 0, s96
    s_lshl_b32 s97, s96, 7
    s_add_u32 m0, s45, 4096
    s_add_u32 s51, s97, 1351680
    buffer_load_dwordx4 v240, s[16:19], s51 offen lds
    s_add_u32 s96, s96, 1
    s_cmp_ge_u32 s96, 10
    s_cselect_b32 s96, 0, s96
    s_lshl_b32 s97, s96, 7
    s_add_u32 m0, s45, 8192
    s_add_u32 s51, s97, 1351680
    buffer_load_dwordx4 v240, s[16:19], s51 offen lds
    s_add_u32 s96, s96, 1
    s_cmp_ge_u32 s96, 10
    s_cselect_b32 s96, 0, s96
    s_lshl_b32 s97, s96, 7
    s_add_u32 m0, s45, 12288
    s_add_u32 s51, s97, 1351680
    buffer_load_dwordx4 v240, s[16:19], s51 offen lds
    s_add_u32 s96, s96, 1
    s_cmp_ge_u32 s96, 10
    s_cselect_b32 s96, 0, s96
    s_lshl_b32 s97, s96, 7
    s_add_u32 m0, s45, 16384
    s_add_u32 s51, s97, 1351680
    buffer_load_dwordx4 v240, s[16:19], s51 offen lds
    s_add_u32 s96, s96, 1
    s_cmp_ge_u32 s96, 10
    s_cselect_b32 s96, 0, s96
    s_waitcnt vmcnt(10)
    s_barrier
    s_lshl_b32 s97, s96, 7
    s_add_u32 m0, s45, 24576
    s_add_u32 s51, s97, 1351680
    buffer_load_dwordx4 v240, s[16:19], s51 offen lds
    s_add_u32 s96, s96, 1
    s_cmp_ge_u32 s96, 10
    s_cselect_b32 s96, 0, s96
    s_lshl_b32 s97, s96, 7
    s_add_u32 m0, s45, 28672
    s_add_u32 s51, s97, 1351680
    buffer_load_dwordx4 v240, s[16:19], s51 offen lds
    s_add_u32 s96, s96, 1
    s_cmp_ge_u32 s96, 10
    s_cselect_b32 s96, 0, s96
    s_lshl_b32 s97, s96, 7
    s_add_u32 m0, s45, 32768
    s_add_u32 s51, s97, 1351680
    buffer_load_dwordx4 v240, s[16:19], s51 offen lds
    s_add_u32 s96, s96, 1
    s_cmp_ge_u32 s96, 10
    s_cselect_b32 s96, 0, s96
    s_lshl_b32 s97, s96, 7
    s_add_u32 m0, s45, 36864
    s_add_u32 s51, s97, 1351680
    buffer_load_dwordx4 v240, s[16:19], s51 offen lds
    s_add_u32 s96, s96, 1
    s_cmp_ge_u32 s96, 10
    s_cselect_b32 s96, 0, s96
    s_lshl_b32 s97, s96, 7
    s_add_u32 m0, s45, 40960
    s_add_u32 s51, s97, 1351680
    buffer_load_dwordx4 v240, s[16:19], s51 offen lds
    s_add_u32 s96, s96, 1
    s_cmp_ge_u32 s96, 10
    s_cselect_b32 s96, 0, s96
    s_waitcnt vmcnt(10)
    s_barrier
    s_waitcnt vmcnt(0)
    s_barrier
    s_branch L_ld_go
L_ld_idle2:
    s_barrier
    global_load_dword v220, v221, s[12:13] sc1
L_ld_go:
    s_mov_b32 s52, 0
L_rdy3:
    s_waitcnt vmcnt(0)
    v_readfirstlane_b32 s44, v220
    s_add_u32 s52, s52, 1
    s_cmp_ge_u32 s52, 400000
    s_cbranch_scc1 L_rdy3_ok
    s_cmp_ge_u32 s44, 64
    s_cbranch_scc1 L_rdy3_ok
    global_load_dword v220, v221, s[12:13] sc1
    s_branch L_rdy3
L_rdy3_ok:
    s_add_u32 m0, s62, 100352
    s_add_u32 s51, s60, 327680
    buffer_load_dwordx4 v234, s[24:27], s51 offen lds
    s_add_u32 m0, s62, 104448
    s_add_u32 s51, s60, 491520
    buffer_load_dwordx4 v230, s[24:27], s51 offen lds
    s_add_u32 m0, s62, 108544
    s_nop 0
    buffer_load_dwordx4 v231, s[24:27], s51 offen lds
    s_add_u32 m0, s62, 112640
    s_nop 0
    buffer_load_dwordx4 v232, s[24:27], s51 offen lds
L_fetch:
    s_mov_b64 exec, 1
    s_mov_b32 s52, 0
L_poll1:
    v_mov_b32 v220, 0
    buffer_atomic_add v220, v222, s[32:35], 0 offen sc0 sc1
    s_add_u32 s52, s52, 1
    s_cmp_ge_u32 s52, 400000
    s_waitcnt vmcnt(0)
    s_cbranch_scc1 L_poll1_out
    v_cmp_gt_u32 vcc, s99, v220
    s_cbranch_vccnz L_poll1
L_poll1_out:
    s_mov_b64 exec, -1
    s_bitcmp1_b32 s98, 0
    s_cbranch_scc0 L_skipu0
    s_add_u32 m0, s100, 36864
    s_mov_b32 s51, 0
    buffer_load_dwordx4 v224, s[32:35], s51 offen sc1 lds
    s_add_u32 m0, s100, 38912
    s_nop 0
    buffer_load_dwordx4 v225, s[32:35], s51 offen sc1 lds
    s_add_u32 m0, s100, 40960
    s_nop 0
    buffer_load_dwordx4 v226, s[32:35], s51 offen sc1 lds
L_skipu0:
    s_bitcmp1_b32 s98, 1
    s_cbranch_scc0 L_skipu1
    s_add_u32 m0, s100, 37888
    s_mov_b32 s51, 1024
    buffer_load_dwordx4 v224, s[32:35], s51 offen sc1 lds
    s_add_u32 m0, s100, 39936
    s_nop 0
    buffer_load_dwordx4 v225, s[32:35], s51 offen sc1 lds
    s_add_u32 m0, s100, 41984
    s_nop 0
    buffer_load_dwordx4 v226, s[32:35], s51 offen sc1 lds
L_skipu1:
    s_bitcmp1_b32 s98, 6
    s_cbranch_scc0 L_skipu6
    s_add_u32 m0, s100, 4096
    s_mov_b32 s51, 2621440
    buffer_load_dwordx4 v224, s[32:35], s51 offen sc1 lds
    s_add_u32 m0, s100, 10240
    s_nop 0
    buffer_load_dwordx4 v225, s[32:35], s51 offen sc1 lds
    s_add_u32 m0, s100, 16384
    s_nop 0
    buffer_load_dwordx4 v226, s[32:35], s51 offen sc1 lds
L_skipu6:
    s_bitcmp1_b32 s98, 7
    s_cbranch_scc0 L_skipu7
    s_add_u32 m0, s100, 5120
    s_mov_b32 s51, 2622464
    buffer_load_dwordx4 v224, s[32:35], s51 offen sc1 lds
    s_add_u32 m0, s100, 11264
    s_nop 0
    buffer_load_dwordx4 v225, s[32:35], s51 offen sc1 lds
    s_add_u32 m0, s100, 17408
    s_nop 0
    buffer_load_dwordx4 v226, s[32:35], s51 offen sc1 lds
L_skipu7:
    s_bitcmp1_b32 s98, 12
    s_cbranch_scc0 L_skipu12
    s_add_u32 m0, s100, 22528
    s_mov_b32 s51, 5242880
    buffer_load_dwordx4 v224, s[32:35], s51 offen sc1 lds
    s_add_u32 m0, s100, 28672
    s_nop 0
    buffer_load_dwordx4 v227, s[32:35], s51 offen sc1 lds
    s_add_u32 m0, s100, 34816
    s_nop 0
    buffer_load_dwordx4 v228, s[32:35], s51 offen sc1 lds
L_skipu12:
    s_bitcmp1_b32 s98, 13
    s_cbranch_scc0 L_skipu13
    s_add_u32 m0, s100, 23552
    s_mov_b32 s51, 5243904
    buffer_load_dwordx4 v224, s[32:35], s51 offen sc1 lds
    s_add_u32 m0, s100, 29696
    s_nop 0
    buffer_load_dwordx4 v227, s[32:35], s51 offen sc1 lds
    s_add_u32 m0, s100, 35840
    s_nop 0
    buffer_load_dwordx4 v228, s[32:35], s51 offen sc1 lds
L_skipu13:
    s_bitcmp1_b32 s98, 4
    s_cbranch_scc0 L_skipu4
    s_add_u32 m0, s100, 2048
    s_mov_b32 s51, 2619392
    buffer_load_dwordx4 v224, s[32:35], s51 offen sc1 lds
    s_add_u32 m0, s100, 8192
    s_nop 0
    buffer_load_dwordx4 v225, s[32:35], s51 offen sc1 lds
    s_add_u32 m0, s100, 14336
    s_nop 0
    buffer_load_dwordx4 v226, s[32:35], s51 offen sc1 lds
L_skipu4:
    s_bitcmp1_b32 s98, 5
    s_cbranch_scc0 L_skipu5
    s_add_u32 m0, s100, 3072
    s_mov_b32 s51, 2620416
    buffer_load_dwordx4 v224, s[32:35], s51 offen sc1 lds
    s_add_u32 m0, s100, 9216
    s_nop 0
    buffer_load_dwordx4 v225, s[32:35], s51 offen sc1 lds
    s_add_u32 m0, s100, 15360
    s_nop 0
    buffer_load_dwordx4 v226, s[32:35], s51 offen sc1 lds
L_skipu5:
    s_bitcmp1_b32 s98, 10
    s_cbranch_scc0 L_skipu10
    s_add_u32 m0, s100, 20480
    s_mov_b32 s51, 5240832
    buffer_load_dwordx4 v224, s[32:35], s51 offen sc1 lds
    s_add_u32 m0, s100, 26624
    s_nop 0
    buffer_load_dwordx4 v227, s[32:35], s51 offen sc1 lds
    s_add_u32 m0, s100, 32768
    s_nop 0
    buffer_load_dwordx4 v228, s[32:35], s51 offen sc1 lds
L_skipu10:
    s_bitcmp1_b32 s98, 11
    s_cbranch_scc0 L_skipu11
    s_add_u32 m0, s100, 21504
    s_mov_b32 s51, 5241856
    buffer_load_dwordx4 v224, s[32:35], s51 offen sc1 lds
    s_add_u32 m0, s100, 27648
    s_nop 0
    buffer_load_dwordx4 v227, s[32:35], s51 offen sc1 lds
    s_add_u32 m0, s100, 33792
    s_nop 0
    buffer_load_dwordx4 v228, s[32:35], s51 offen sc1 lds
L_skipu11:
    s_bitcmp1_b32 s98, 2
    s_cbranch_scc0 L_skipu2
    s_add_u32 m0, s100, 0
    s_mov_b32 s51, 2617344
    buffer_load_dwordx4 v224, s[32:35], s51 offen sc1 lds
    s_add_u32 m0, s100, 6144
    s_nop 0
    buffer_load_dwordx4 v225, s[32:35], s51 offen sc1 lds
    s_add_u32 m0, s100, 12288
    s_nop 0
    buffer_load_dwordx4 v226, s[32:35], s51 offen sc1 lds
L_skipu2:
    s_bitcmp1_b32 s98, 3
    s_cbranch_scc0 L_skipu3
    s_add_u32 m0, s100, 1024
    s_mov_b32 s51, 2618368
    buffer_load_dwordx4 v224, s[32:35], s51 offen sc1 lds
    s_add_u32 m0, s100, 7168
    s_nop 0
    buffer_load_dwordx4 v225, s[32:35], s51 offen sc1 lds
    s_add_u32 m0, s100, 13312
    s_nop 0
    buffer_load_dwordx4 v226, s[32:35], s51 offen sc1 lds
L_skipu3:
    s_bitcmp1_b32 s98, 8
    s_cbranch_scc0 L_skipu8
    s_add_u32 m0, s100, 18432
    s_mov_b32 s51, 5238784
    buffer_load_dwordx4 v224, s[32:35], s51 offen sc1 lds
    s_add_u32 m0, s100, 24576
    s_nop 0
    buffer_load_dwordx4 v227, s[32:35], s51 offen sc1 lds
    s_add_u32 m0, s100, 30720
    s_nop 0
    buffer_load_dwordx4 v228, s[32:35], s51 offen sc1 lds
L_skipu8:
    s_bitcmp1_b32 s98, 9
    s_cbranch_scc0 L_skipu9
    s_add_u32 m0, s100, 19456
    s_mov_b32 s51, 5239808
    buffer_load_dwordx4 v224, s[32:35], s51 offen sc1 lds
    s_add_u32 m0, s100, 25600
    s_nop 0
    buffer_load_dwordx4 v227, s[32:35], s51 offen sc1 lds
    s_add_u32 m0, s100, 31744
    s_nop 0
    buffer_load_dwordx4 v228, s[32:35], s51 offen sc1 lds
L_skipu9:
    s_lshl_b32 s46, s61, 2
    v_add_u32 v24, s46, v9
    v_mov_b32 v26, 1
    s_mov_b64 exec, 1
    s_waitcnt vmcnt(0)
    ds_add_u32 v24, v26
    s_mov_b64 exec, -1
L_wland:
    ds_read_b32 v25, v24 offset:0
    s_waitcnt lgkmcnt(0)
    v_cmp_gt_u32 vcc, 4, v25
    s_cbranch_vccnz L_wland
    s_cmp_eq_u32 s61, 0
    s_cbranch_scc1 L_np
    s_setprio 1
    s_cmp_ge_u32 s40, 15
    s_cbranch_scc1 L_np
L_wp1e:
    ds_read_b32 v25, v9 offset:8
    s_waitcnt lgkmcnt(0)
    v_cmp_gt_u32 vcc, 4, v25
    s_cbranch_vccnz L_wp1e
L_np:
    s_mov_b64 exec, 0x3ffff
    ds_write_b64 v8, v[22:23]
    s_mov_b64 exec, -1
    ds_read_b128 v[16:19], v10
    ds_read_b64 v[20:21], v11
    ds_read_b128 v[104:107], v2 offset:4096
    ds_read_b64 v[108:109], v3 offset:4096
    ds_read_b128 v[112:115], v2 offset:0
    ds_read_b64 v[116:117], v3 offset:0
    ds_read_b64_tr_b16 v[120:121], v4 offset:4096
    ds_read_b64_tr_b16 v[122:123], v5 offset:4096
    ds_read_b64_tr_b16 v[124:125], v4 offset:4352
    ds_read_b64_tr_b16 v[126:127], v5 offset:4352
    ds_read_b64_tr_b16 v[128:129], v4 offset:0
    ds_read_b64_tr_b16 v[130:131], v5 offset:0
    ds_read_b64_tr_b16 v[132:133], v4 offset:256
    ds_read_b64_tr_b16 v[134:135], v5 offset:256
    s_waitcnt lgkmcnt(12)
    v_cndmask_b32 v20, v20, 0, s[54:55]
    v_cndmask_b32 v21, v21, 0, s[54:55]
    s_waitcnt lgkmcnt(10)
    s_cmp_eq_u32 s63, 0
    v_mfma_f32_32x32x16_bf16 v[64:79], v[104:107], v[16:19], 0
    v_mfma_f32_32x32x8_bf16 v[64:79], v[108:109], v[20:21], v[64:79]
    s_cbranch_scc1 L_nofar
    s_waitcnt lgkmcnt(8)
    v_mfma_f32_32x32x16_bf16 v[80:95], v[112:115], v[16:19], 0
    v_mfma_f32_32x32x8_bf16 v[80:95], v[116:117], v[20:21], v[80:95]
L_far_done:
    ds_read_b128 v[104:107], v2 offset:3584
    ds_read_b64 v[108:109], v3 offset:3584
    s_cmp_eq_u32 s61, 0
    s_cbranch_scc1 L_nw0
    s_add_u32 m0, s62, 43008
    s_add_u32 s51, s60, 0
    buffer_load_dwordx4 v230, s[24:27], s51 offen lds
    s_add_u32 m0, s62, 47104
    s_nop 0
    buffer_load_dwordx4 v231, s[24:27], s51 offen lds
    s_add_u32 m0, s62, 51200
    s_nop 0
    buffer_load_dwordx4 v232, s[24:27], s51 offen lds
    s_add_u32 m0, s62, 55296
    s_nop 0
    buffer_load_dwordx4 v233, s[24:27], s51 offen lds
    s_add_u32 m0, s62, 59392
    s_nop 0
    buffer_load_dwordx4 v234, s[24:27], s51 offen lds
L_nw0:
    s_nop 7
    v_bfi_b32 v64, v32, v64, v80
    v_bfi_b32 v65, v33, v65, v81
    v_bfi_b32 v66, v34, v66, v82
    v_bfi_b32 v67, v35, v67, v83
    v_bfi_b32 v68, v36, v68, v84
    v_bfi_b32 v69, v37, v69, v85
    v_bfi_b32 v70, v38, v70, v86
    v_bfi_b32 v71, v39, v71, v87
    v_bfi_b32 v72, v40, v72, v88
    v_bfi_b32 v73, v41, v73, v89
    v_bfi_b32 v74, v42, v74, v90
    v_bfi_b32 v75, v43, v75, v91
    v_bfi_b32 v76, v44, v76, v92
    v_bfi_b32 v77, v45, v77, v93
    v_bfi_b32 v78, v46, v78, v94
    v_bfi_b32 v79, v47, v79, v95
    v_max3_f32 v25, v64, v65, v66
    v_max3_f32 v26, v67, v68, v69
    v_max3_f32 v25, v25, v70, v71
    v_max3_f32 v26, v26, v72, v73
    v_max3_f32 v25, v25, v74, v75
    v_max3_f32 v26, v26, v76, v77
    v_max3_f32 v25, v25, v78, v79
    v_max_f32 v25, v25, v26
    v_mov_b32 v26, v25
    s_nop 1
    v_permlane32_swap_b32 v25, v26
    v_max_f32 v25, v25, v26
    v_and_b32 v25, 0xffff0000, v25
    v_lshrrev_b32 v26, 16, v25
    v_xor_b32 v26, 0x8000, v26
    v_cndmask_b32 v20, v20, v26, s[54:55]
    v_sub_f32 v64, v64, v25
    v_sub_f32 v65, v65, v25
    v_sub_f32 v66, v66, v25
    v_sub_f32 v67, v67, v25
    s_waitcnt lgkmcnt(0)
    v_mfma_f32_32x32x16_bf16 v[80:95], v[104:107], v[16:19], 0
    v_mfma_f32_32x32x8_bf16 v[80:95], v[108:109], v[20:21], v[80:95]
    ds_read_b128 v[112:115], v2 offset:3072
    ds_read_b64 v[116:117], v3 offset:3072
    v_sub_f32 v68, v68, v25
    v_sub_f32 v69, v69, v25
    v_sub_f32 v70, v70, v25
    v_sub_f32 v71, v71, v25
    v_sub_f32 v72, v72, v25
    v_sub_f32 v73, v73, v25
    v_sub_f32 v74, v74, v25
    v_sub_f32 v75, v75, v25
    v_sub_f32 v76, v76, v25
    v_sub_f32 v77, v77, v25
    v_sub_f32 v78, v78, v25
    v_sub_f32 v79, v79, v25
    v_exp_f32 v64, v64
    v_exp_f32 v65, v65
    v_exp_f32 v66, v66
    v_exp_f32 v67, v67
    v_exp_f32 v68, v68
    v_exp_f32 v69, v69
    v_exp_f32 v70, v70
    v_exp_f32 v71, v71
    v_cvt_pk_bf16_f32 v96, v64, v65
    v_cvt_pk_bf16_f32 v97, v66, v67
    v_cvt_pk_bf16_f32 v98, v68, v69
    v_cvt_pk_bf16_f32 v99, v70, v71
    v_and_b32 v56, v48, v96
    v_and_b32 v57, v49, v97
    v_and_b32 v58, v50, v98
    v_and_b32 v59, v51, v99
    v_xor_b32 v96, v56, v96
    v_xor_b32 v97, v57, v97
    v_xor_b32 v98, v58, v98
    v_xor_b32 v99, v59, v99
    v_exp_f32 v72, v72
    v_exp_f32 v73, v73
    v_mfma_f32_32x32x16_bf16 v[136:151], v[120:123], v[56:59], 0
    v_exp_f32 v74, v74
    v_exp_f32 v75, v75
    v_exp_f32 v76, v76
    s_cmp_eq_u32 s63, 0
    s_cbranch_scc1 L_nofar1
    v_mfma_f32_32x32x16_bf16 v[136:151], v[128:131], v[96:99], v[136:151]
L_nofar1:
    v_exp_f32 v77, v77
    v_exp_f32 v78, v78
    v_exp_f32 v79, v79
    s_nop 0
    v_cvt_pk_bf16_f32 v100, v72, v73
    v_cvt_pk_bf16_f32 v101, v74, v75
    v_cvt_pk_bf16_f32 v102, v76, v77
    v_cvt_pk_bf16_f32 v103, v78, v79
    v_and_b32 v60, v52, v100
    v_and_b32 v61, v53, v101
    v_and_b32 v62, v54, v102
    v_and_b32 v63, v55, v103
    v_xor_b32 v100, v60, v100
    v_xor_b32 v101, v61, v101
    v_xor_b32 v102, v62, v102
    v_xor_b32 v103, v63, v103
    v_mfma_f32_32x32x16_bf16 v[136:151], v[124:127], v[60:63], v[136:151]
    s_cbranch_scc1 L_nofar2
    v_mfma_f32_32x32x16_bf16 v[136:151], v[132:135], v[100:103], v[136:151]
L_nofar2:
    ds_read_b64_tr_b16 v[120:121], v4 offset:3584
    ds_read_b64_tr_b16 v[122:123], v5 offset:3584
    ds_read_b64_tr_b16 v[124:125], v4 offset:3840
    ds_read_b64_tr_b16 v[126:127], v5 offset:3840
    s_cmp_eq_u32 s58, 0
    s_cbranch_scc1 L_wr1
    s_waitcnt lgkmcnt(4)
    v_mfma_f32_32x32x16_bf16 v[64:79], v[112:115], v[16:19], 0
    v_exp_f32 v80, v80
    v_exp_f32 v81, v81
    v_exp_f32 v82, v82
    ds_read_b128 v[104:107], v2 offset:2560
    ds_read_b64 v[108:109], v3 offset:2560
    v_mfma_f32_32x32x8_bf16 v[64:79], v[116:117], v[20:21], v[64:79]
    s_cmp_eq_u32 s61, 0
    s_cbranch_scc1 L_nw1
    s_add_u32 m0, s62, 63488
    s_add_u32 s51, s60, 163840
    buffer_load_dwordx4 v230, s[24:27], s51 offen lds
    s_add_u32 m0, s62, 67584
    s_nop 0
    buffer_load_dwordx4 v231, s[24:27], s51 offen lds
    s_add_u32 m0, s62, 71680
    s_nop 0
    buffer_load_dwordx4 v232, s[24:27], s51 offen lds
    s_add_u32 m0, s62, 75776
    s_nop 0
    buffer_load_dwordx4 v233, s[24:27], s51 offen lds
    s_add_u32 m0, s62, 79872
    s_nop 0
    buffer_load_dwordx4 v234, s[24:27], s51 offen lds
L_nw1:
    v_exp_f32 v83, v83
    v_exp_f32 v84, v84
    v_exp_f32 v85, v85
    v_exp_f32 v86, v86
    v_exp_f32 v87, v87
    v_cvt_pk_bf16_f32 v96, v80, v81
    v_cvt_pk_bf16_f32 v97, v82, v83
    v_cvt_pk_bf16_f32 v98, v84, v85
    v_exp_f32 v88, v88
    v_cvt_pk_bf16_f32 v99, v86, v87
    v_exp_f32 v89, v89
    v_exp_f32 v90, v90
    s_waitcnt lgkmcnt(2)
    v_mfma_f32_32x32x16_bf16 v[136:151], v[120:123], v[96:99], v[136:151]
    v_exp_f32 v91, v91
    v_exp_f32 v92, v92
    v_exp_f32 v93, v93
    v_exp_f32 v94, v94
    v_exp_f32 v95, v95
    v_cvt_pk_bf16_f32 v100, v88, v89
    v_cvt_pk_bf16_f32 v101, v90, v91
    v_cvt_pk_bf16_f32 v102, v92, v93
    ds_read_b64_tr_b16 v[128:129], v4 offset:3072
    ds_read_b64_tr_b16 v[130:131], v5 offset:3072
    ds_read_b64_tr_b16 v[132:133], v4 offset:3328
    ds_read_b64_tr_b16 v[134:135], v5 offset:3328
    v_cvt_pk_bf16_f32 v103, v94, v95
    s_nop 1
    v_mfma_f32_32x32x16_bf16 v[136:151], v[124:127], v[100:103], v[136:151]
    s_cmp_eq_u32 s58, 1
    s_cbranch_scc1 L_wr2
    s_waitcnt lgkmcnt(4)
    v_mfma_f32_32x32x16_bf16 v[80:95], v[104:107], v[16:19], 0
    v_exp_f32 v64, v64
    v_exp_f32 v65, v65
    v_exp_f32 v66, v66
    ds_read_b128 v[112:115], v2 offset:2048
    ds_read_b64 v[116:117], v3 offset:2048
    v_mfma_f32_32x32x8_bf16 v[80:95], v[108:109], v[20:21], v[80:95]
    v_exp_f32 v67, v67
    v_exp_f32 v68, v68
    v_exp_f32 v69, v69
    v_exp_f32 v70, v70
    v_exp_f32 v71, v71
    v_cvt_pk_bf16_f32 v96, v64, v65
    v_cvt_pk_bf16_f32 v97, v66, v67
    v_cvt_pk_bf16_f32 v98, v68, v69
    v_exp_f32 v72, v72
    v_cvt_pk_bf16_f32 v99, v70, v71
    v_exp_f32 v73, v73
    v_exp_f32 v74, v74
    s_waitcnt lgkmcnt(2)
    v_mfma_f32_32x32x16_bf16 v[136:151], v[128:131], v[96:99], v[136:151]
    v_exp_f32 v75, v75
    v_exp_f32 v76, v76
    v_exp_f32 v77, v77
    v_exp_f32 v78, v78
    v_exp_f32 v79, v79
    v_cvt_pk_bf16_f32 v100, v72, v73
    v_cvt_pk_bf16_f32 v101, v74, v75
    v_cvt_pk_bf16_f32 v102, v76, v77
    ds_read_b64_tr_b16 v[120:121], v4 offset:2560
    ds_read_b64_tr_b16 v[122:123], v5 offset:2560
    ds_read_b64_tr_b16 v[124:125], v4 offset:2816
    ds_read_b64_tr_b16 v[126:127], v5 offset:2816
    v_cvt_pk_bf16_f32 v103, v78, v79
    s_nop 1
    v_mfma_f32_32x32x16_bf16 v[136:151], v[132:135], v[100:103], v[136:151]
    s_cmp_eq_u32 s58, 2
    s_cbranch_scc1 L_p2_done
    s_waitcnt lgkmcnt(4)
    v_mfma_f32_32x32x16_bf16 v[64:79], v[112:115], v[16:19], 0
    v_exp_f32 v80, v80
    v_exp_f32 v81, v81
    v_exp_f32 v82, v82
    ds_read_b128 v[104:107], v2 offset:1536
    ds_read_b64 v[108:109], v3 offset:1536
    v_mfma_f32_32x32x8_bf16 v[64:79], v[116:117], v[20:21], v[64:79]
    v_exp_f32 v83, v83
    v_exp_f32 v84, v84
    v_exp_f32 v85, v85
    v_exp_f32 v86, v86
    v_exp_f32 v87, v87
    v_cvt_pk_bf16_f32 v96, v80, v81
    v_cvt_pk_bf16_f32 v97, v82, v83
    v_cvt_pk_bf16_f32 v98, v84, v85
    v_exp_f32 v88, v88
    v_cvt_pk_bf16_f32 v99, v86, v87
    v_exp_f32 v89, v89
    v_exp_f32 v90, v90
    s_waitcnt lgkmcnt(2)
    v_mfma_f32_32x32x16_bf16 v[136:151], v[120:123], v[96:99], v[136:151]
    v_exp_f32 v91, v91
    v_exp_f32 v92, v92
    v_exp_f32 v93, v93
    v_exp_f32 v94, v94
    v_exp_f32 v95, v95
    v_cvt_pk_bf16_f32 v100, v88, v89
    v_cvt_pk_bf16_f32 v101, v90, v91
    v_cvt_pk_bf16_f32 v102, v92, v93
    ds_read_b64_tr_b16 v[128:129], v4 offset:2048
    ds_read_b64_tr_b16 v[130:131], v5 offset:2048
    ds_read_b64_tr_b16 v[132:133], v4 offset:2304
    ds_read_b64_tr_b16 v[134:135], v5 offset:2304
    v_cvt_pk_bf16_f32 v103, v94, v95
    s_nop 1
    v_mfma_f32_32x32x16_bf16 v[136:151], v[124:127], v[100:103], v[136:151]
    s_cmp_eq_u32 s58, 3
    s_cbranch_scc1 L_p2_done
    s_waitcnt lgkmcnt(4)
    v_mfma_f32_32x32x16_bf16 v[80:95], v[104:107], v[16:19], 0
    v_exp_f32 v64, v64
    v_exp_f32 v65, v65
    v_exp_f32 v66, v66
    ds_read_b128 v[112:115], v2 offset:1024
    ds_read_b64 v[116:117], v3 offset:1024
    v_mfma_f32_32x32x8_bf16 v[80:95], v[108:109], v[20:21], v[80:95]
    v_exp_f32 v67, v67
    v_exp_f32 v68, v68
    v_exp_f32 v69, v69
    v_exp_f32 v70, v70
    v_exp_f32 v71, v71
    v_cvt_pk_bf16_f32 v96, v64, v65
    v_cvt_pk_bf16_f32 v97, v66, v67
    v_cvt_pk_bf16_f32 v98, v68, v69
    v_exp_f32 v72, v72
    v_cvt_pk_bf16_f32 v99, v70, v71
    v_exp_f32 v73, v73
    v_exp_f32 v74, v74
    s_waitcnt lgkmcnt(2)
    v_mfma_f32_32x32x16_bf16 v[136:151], v[128:131], v[96:99], v[136:151]
    v_exp_f32 v75, v75
    v_exp_f32 v76, v76
    v_exp_f32 v77, v77
    v_exp_f32 v78, v78
    v_exp_f32 v79, v79
    v_cvt_pk_bf16_f32 v100, v72, v73
    v_cvt_pk_bf16_f32 v101, v74, v75
    v_cvt_pk_bf16_f32 v102, v76, v77
    ds_read_b64_tr_b16 v[120:121], v4 offset:1536
    ds_read_b64_tr_b16 v[122:123], v5 offset:1536
    ds_read_b64_tr_b16 v[124:125], v4 offset:1792
    ds_read_b64_tr_b16 v[126:127], v5 offset:1792
    v_cvt_pk_bf16_f32 v103, v78, v79
    s_nop 1
    v_mfma_f32_32x32x16_bf16 v[136:151], v[132:135], v[100:103], v[136:151]
    s_cmp_eq_u32 s58, 4
    s_cbranch_scc1 L_p2_done
    s_waitcnt lgkmcnt(4)
    v_mfma_f32_32x32x16_bf16 v[64:79], v[112:115], v[16:19], 0
    v_exp_f32 v80, v80
    v_exp_f32 v81, v81
    v_exp_f32 v82, v82
    ds_read_b128 v[104:107], v2 offset:512
    ds_read_b64 v[108:109], v3 offset:512
    v_mfma_f32_32x32x8_bf16 v[64:79], v[116:117], v[20:21], v[64:79]
    v_exp_f32 v83, v83
    v_exp_f32 v84, v84
    v_exp_f32 v85, v85
    v_exp_f32 v86, v86
    v_exp_f32 v87, v87
    v_cvt_pk_bf16_f32 v96, v80, v81
    v_cvt_pk_bf16_f32 v97, v82, v83
    v_cvt_pk_bf16_f32 v98, v84, v85
    v_exp_f32 v88, v88
    v_cvt_pk_bf16_f32 v99, v86, v87
    v_exp_f32 v89, v89
    v_exp_f32 v90, v90
    s_waitcnt lgkmcnt(2)
    v_mfma_f32_32x32x16_bf16 v[136:151], v[120:123], v[96:99], v[136:151]
    v_exp_f32 v91, v91
    v_exp_f32 v92, v92
    v_exp_f32 v93, v93
    v_exp_f32 v94, v94
    v_exp_f32 v95, v95
    v_cvt_pk_bf16_f32 v100, v88, v89
    v_cvt_pk_bf16_f32 v101, v90, v91
    v_cvt_pk_bf16_f32 v102, v92, v93
    ds_read_b64_tr_b16 v[128:129], v4 offset:1024
    ds_read_b64_tr_b16 v[130:131], v5 offset:1024
    ds_read_b64_tr_b16 v[132:133], v4 offset:1280
    ds_read_b64_tr_b16 v[134:135], v5 offset:1280
    v_cvt_pk_bf16_f32 v103, v94, v95
    s_nop 1
    v_mfma_f32_32x32x16_bf16 v[136:151], v[124:127], v[100:103], v[136:151]
    s_cmp_eq_u32 s58, 5
    s_cbranch_scc1 L_p2_done
    s_waitcnt lgkmcnt(4)
    v_mfma_f32_32x32x16_bf16 v[80:95], v[104:107], v[16:19], 0
    v_exp_f32 v64, v64
    v_exp_f32 v65, v65
    v_exp_f32 v66, v66
    v_mfma_f32_32x32x8_bf16 v[80:95], v[108:109], v[20:21], v[80:95]
    v_exp_f32 v67, v67
    v_exp_f32 v68, v68
    v_exp_f32 v69, v69
    v_exp_f32 v70, v70
    v_exp_f32 v71, v71
    v_cvt_pk_bf16_f32 v96, v64, v65
    v_cvt_pk_bf16_f32 v97, v66, v67
    v_cvt_pk_bf16_f32 v98, v68, v69
    v_exp_f32 v72, v72
    v_cvt_pk_bf16_f32 v99, v70, v71
    v_exp_f32 v73, v73
    v_exp_f32 v74, v74
    s_waitcnt lgkmcnt(0)
    v_mfma_f32_32x32x16_bf16 v[136:151], v[128:131], v[96:99], v[136:151]
    v_exp_f32 v75, v75
    v_exp_f32 v76, v76
    v_exp_f32 v77, v77
    v_exp_f32 v78, v78
    v_exp_f32 v79, v79
    v_cvt_pk_bf16_f32 v100, v72, v73
    v_cvt_pk_bf16_f32 v101, v74, v75
    v_cvt_pk_bf16_f32 v102, v76, v77
    ds_read_b64_tr_b16 v[120:121], v4 offset:512
    ds_read_b64_tr_b16 v[122:123], v5 offset:512
    ds_read_b64_tr_b16 v[124:125], v4 offset:768
    ds_read_b64_tr_b16 v[126:127], v5 offset:768
    v_cvt_pk_bf16_f32 v103, v78, v79
    s_nop 1
    v_mfma_f32_32x32x16_bf16 v[136:151], v[132:135], v[100:103], v[136:151]
    s_cmp_eq_u32 s58, 6
    s_cbranch_scc1 L_p2_done
    v_exp_f32 v80, v80
    v_exp_f32 v81, v81
    v_exp_f32 v82, v82
    v_exp_f32 v83, v83
    v_exp_f32 v84, v84
    v_exp_f32 v85, v85
    v_exp_f32 v86, v86
    v_exp_f32 v87, v87
    v_cvt_pk_bf16_f32 v96, v80, v81
    v_cvt_pk_bf16_f32 v97, v82, v83
    v_cvt_pk_bf16_f32 v98, v84, v85
    v_exp_f32 v88, v88
    v_cvt_pk_bf16_f32 v99, v86, v87
    v_exp_f32 v89, v89
    v_exp_f32 v90, v90
    s_waitcnt lgkmcnt(0)
    v_mfma_f32_32x32x16_bf16 v[136:151], v[120:123], v[96:99], v[136:151]
    v_exp_f32 v91, v91
    v_exp_f32 v92, v92
    v_exp_f32 v93, v93
    v_exp_f32 v94, v94
    v_exp_f32 v95, v95
    v_cvt_pk_bf16_f32 v100, v88, v89
    v_cvt_pk_bf16_f32 v101, v90, v91
    v_cvt_pk_bf16_f32 v102, v92, v93
    v_cvt_pk_bf16_f32 v103, v94, v95
    s_nop 1
    v_mfma_f32_32x32x16_bf16 v[136:151], v[124:127], v[100:103], v[136:151]
L_p2_done:
    s_lshl_b32 s48, s42, 5
    s_add_u32 s48, s48, s101
    s_lshl_b32 s48, s48, 1
    s_xor_b32 s49, s61, 1
    s_add_u32 s48, s48, s49
    s_lshl_b32 s48, s48, 7
    s_add_u32 s53, s48, 12648448
    v_mov_b32 v27, 0x5d800000
    v_mov_b32 v30, 0x21800000
    v_mov_b32 v28, 1
    v_lshlrev_b32 v29, 10, v0
    s_nop 0
    v_mov_b32 v25, v144
    v_mov_b32 v26, v144
    s_nop 1
    v_permlane32_swap_b32 v25, v26
    v_cmp_nlt_f32 vcc, v26, v27
    v_cmp_ngt_f32 s[46:47], v26, v30
    s_or_b64 vcc, vcc, s[46:47]
    s_cbranch_vccnz L_slow
L_p2_norm:
    v_rcp_f32 v26, v26
    s_nop 0
    v_mul_f32 v136, v136, v26
    v_mul_f32 v137, v137, v26
    v_mul_f32 v138, v138, v26
    v_mul_f32 v139, v139, v26
    v_mul_f32 v140, v140, v26
    v_mul_f32 v141, v141, v26
    v_mul_f32 v142, v142, v26
    v_mul_f32 v143, v143, v26
    v_mul_f32 v144, v144, v26
    v_mul_f32 v145, v145, v26
    v_mul_f32 v146, v146, v26
    v_mul_f32 v147, v147, v26
    v_cvt_pk_bf16_f32 v96, v136, v137
    v_cvt_pk_bf16_f32 v97, v138, v139
    v_cvt_pk_bf16_f32 v98, v140, v141
    v_cvt_pk_bf16_f32 v99, v142, v143
    v_cvt_pk_bf16_f32 v100, v144, v145
    v_cvt_pk_bf16_f32 v101, v146, v147
    v_permlane32_swap_b32 v96, v98
    v_permlane32_swap_b32 v97, v99
    buffer_store_dwordx4 v[96:99], v6, s[32:35], 0 offen sc1
    s_mov_b32 exec_hi, 0
    buffer_store_dwordx2 v[100:101], v7, s[32:35], 0 offen sc1
    s_cmp_eq_u32 s61, 1
    s_cbranch_scc1 L_wo
    s_mov_b32 exec_lo, 1
    s_waitcnt lgkmcnt(0)
    ds_add_u32 v9, v28 offset:12
    s_movk_i32 exec_lo, 0xff
    s_waitcnt vmcnt(0)
    buffer_atomic_add v28, v29, s[32:35], s53 offen sc1
L_p3:
    s_mov_b64 exec, -1
    v_mov_b32 v12, v9
    s_mov_b32 s28, s10
    s_mov_b32 s29, s11
    s_mov_b32 s30, 2621440
    s_mov_b32 s31, 0x20000
    s_and_b32 s50, s101, 1
    v_lshrrev_b32 v2, 2, v0
    v_mul_u32_u24 v2, 160, v2
    v_and_b32 v3, 3, v0
    v_lshl_add_u32 v2, v3, 3, v2
    s_mul_i32 s51, s50, 51200
    s_add_u32 s51, s51, 43008
    v_add_u32 v2, s51, v2
    v_lshrrev_b32 v4, 4, v0
    v_and_b32 v5, 15, v0
    v_lshlrev_b32 v6, 15, v4
    v_lshl_add_u32 v6, v5, 4, v6
    s_xor_b32 s49, s61, 1
    s_and_b32 s47, s38, 3
    s_lshl_b32 s48, s49, 5
    s_add_u32 s47, s47, s48
    s_lshl_b32 s46, s37, 2
    s_add_u32 s46, s46, s47
    s_lshl_b32 s48, s37, 5
    s_add_u32 s48, s48, s38
    s_lshl_b32 s48, s48, 1
    s_add_u32 s48, s48, s49
    s_lshl_b32 s48, s48, 7
    s_add_u32 s48, s48, 12648448
    v_mov_b32 v10, s48
    s_lshl_b32 s46, s46, 5
    s_lshr_b32 s47, s101, 1
    s_lshl_b32 s47, s47, 4
    s_add_u32 s46, s46, s47
    s_lshl_b32 s47, s46, 4
    s_add_u32 s47, s47, 8388608
    s_mul_i32 s51, s50, 1310720
    s_add_u32 s47, s47, s51
    v_add_u32 v7, s46, v5
    v_mul_u32_u24 v7, 1280, v7
    s_mul_i32 s48, s42, 160
    s_mul_i32 s51, s50, 96
    s_add_u32 s48, s48, s51
    v_add_u32 v7, s48, v7
    v_lshl_add_u32 v9, v4, 3, v7
    v_and_b32 v11, 1, v4
    v_lshl_add_u32 v7, v11, 5, v7
    v_lshrrev_b32 v11, 1, v4
    v_lshl_add_u32 v7, v11, 4, v7
    s_mul_i32 s48, s61, 145408
    s_mul_i32 s49, s101, 3072
    s_add_u32 s49, s49, s48
    v_lshlrev_b32 v13, 4, v0
    s_xor_b32 s51, s101, 1
    s_mul_i32 s51, s51, 3072
    s_add_u32 s51, s51, s48
    v_add_u32 v14, s51, v13
    v_add_u32 v13, s49, v13
    s_lshl_b32 s48, s36, 2
    v_add_u32 v15, s48, v12
    v_xor_b32 v8, 4, v15
    s_lshl_b32 s48, s61, 2
    v_add_u32 v3, s48, v12
L_cwo:
    ds_read_b32 v11, v12 offset:20
    s_waitcnt lgkmcnt(0)
    v_cmp_gt_u32 vcc, 4, v11
    s_cbranch_vccnz L_cwo
    ds_read_b64_tr_b16 v[56:57], v2 offset:0
    ds_read_b64_tr_b16 v[58:59], v2 offset:2560
    ds_read_b64_tr_b16 v[60:61], v2 offset:32
    ds_read_b64_tr_b16 v[62:63], v2 offset:2592
    ds_read_b64_tr_b16 v[64:65], v2 offset:64
    ds_read_b64_tr_b16 v[66:67], v2 offset:2624
    ds_read_b64_tr_b16 v[68:69], v2 offset:96
    ds_read_b64_tr_b16 v[70:71], v2 offset:2656
    ds_read_b64_tr_b16 v[72:73], v2 offset:128
    ds_read_b64_tr_b16 v[74:75], v2 offset:2688
    s_waitcnt lgkmcnt(5)
    ds_read_b64_tr_b16 v[76:77], v2 offset:5120
    ds_read_b64_tr_b16 v[78:79], v2 offset:7680
    ds_read_b64_tr_b16 v[80:81], v2 offset:5152
    ds_read_b64_tr_b16 v[82:83], v2 offset:7712
    ds_read_b64_tr_b16 v[84:85], v2 offset:5184
    ds_read_b64_tr_b16 v[86:87], v2 offset:7744
    ds_read_b64_tr_b16 v[88:89], v2 offset:5216
    ds_read_b64_tr_b16 v[90:91], v2 offset:7776
    ds_read_b64_tr_b16 v[92:93], v2 offset:5248
    ds_read_b64_tr_b16 v[94:95], v2 offset:7808
    s_waitcnt lgkmcnt(5)
    ds_read_b64_tr_b16 v[96:97], v2 offset:10240
    ds_read_b64_tr_b16 v[98:99], v2 offset:12800
    ds_read_b64_tr_b16 v[100:101], v2 offset:10272
    ds_read_b64_tr_b16 v[102:103], v2 offset:12832
    ds_read_b64_tr_b16 v[104:105], v2 offset:10304
    ds_read_b64_tr_b16 v[106:107], v2 offset:12864
    ds_read_b64_tr_b16 v[108:109], v2 offset:10336
    ds_read_b64_tr_b16 v[110:111], v2 offset:12896
    ds_read_b64_tr_b16 v[112:113], v2 offset:10368
    ds_read_b64_tr_b16 v[114:115], v2 offset:12928
    s_waitcnt lgkmcnt(5)
    ds_read_b64_tr_b16 v[116:117], v2 offset:15360
    ds_read_b64_tr_b16 v[118:119], v2 offset:17920
    ds_read_b64_tr_b16 v[120:121], v2 offset:15392
    ds_read_b64_tr_b16 v[122:123], v2 offset:17952
    ds_read_b64_tr_b16 v[124:125], v2 offset:15424
    ds_read_b64_tr_b16 v[126:127], v2 offset:17984
    ds_read_b64_tr_b16 v[128:129], v2 offset:15456
    ds_read_b64_tr_b16 v[130:131], v2 offset:18016
    ds_read_b64_tr_b16 v[132:133], v2 offset:15488
    ds_read_b64_tr_b16 v[134:135], v2 offset:18048
    s_waitcnt lgkmcnt(5)
    ds_read_b64_tr_b16 v[136:137], v2 offset:20480
    ds_read_b64_tr_b16 v[138:139], v2 offset:23040
    ds_read_b64_tr_b16 v[140:141], v2 offset:20512
    ds_read_b64_tr_b16 v[142:143], v2 offset:23072
    ds_read_b64_tr_b16 v[144:145], v2 offset:20544
    ds_read_b64_tr_b16 v[146:147], v2 offset:23104
    ds_read_b64_tr_b16 v[148:149], v2 offset:20576
    ds_read_b64_tr_b16 v[150:151], v2 offset:23136
    ds_read_b64_tr_b16 v[152:153], v2 offset:20608
    ds_read_b64_tr_b16 v[154:155], v2 offset:23168
    s_waitcnt lgkmcnt(5)
    ds_read_b64_tr_b16 v[156:157], v2 offset:25600
    ds_read_b64_tr_b16 v[158:159], v2 offset:28160
    ds_read_b64_tr_b16 v[160:161], v2 offset:25632
    ds_read_b64_tr_b16 v[162:163], v2 offset:28192
    ds_read_b64_tr_b16 v[164:165], v2 offset:25664
    ds_read_b64_tr_b16 v[166:167], v2 offset:28224
    ds_read_b64_tr_b16 v[168:169], v2 offset:25696
    ds_read_b64_tr_b16 v[170:171], v2 offset:28256
    ds_read_b64_tr_b16 v[172:173], v2 offset:25728
    ds_read_b64_tr_b16 v[174:175], v2 offset:28288
    s_waitcnt lgkmcnt(5)
    ds_read_b64_tr_b16 v[176:177], v2 offset:30720
    ds_read_b64_tr_b16 v[178:179], v2 offset:33280
    ds_read_b64_tr_b16 v[180:181], v2 offset:30752
    ds_read_b64_tr_b16 v[182:183], v2 offset:33312
    ds_read_b64_tr_b16 v[184:185], v2 offset:30784
    ds_read_b64_tr_b16 v[186:187], v2 offset:33344
    ds_read_b64_tr_b16 v[188:189], v2 offset:30816
    ds_read_b64_tr_b16 v[190:191], v2 offset:33376
    ds_read_b64_tr_b16 v[192:193], v2 offset:30848
    ds_read_b64_tr_b16 v[194:195], v2 offset:33408
    s_waitcnt lgkmcnt(5)
    ds_read_b64_tr_b16 v[196:197], v2 offset:35840
    ds_read_b64_tr_b16 v[198:199], v2 offset:38400
    ds_read_b64_tr_b16 v[200:201], v2 offset:35872
    ds_read_b64_tr_b16 v[202:203], v2 offset:38432
    ds_read_b64_tr_b16 v[204:205], v2 offset:35904
    ds_read_b64_tr_b16 v[206:207], v2 offset:38464
    ds_read_b64_tr_b16 v[208:209], v2 offset:35936
    ds_read_b64_tr_b16 v[210:211], v2 offset:38496
    ds_read_b64_tr_b16 v[212:213], v2 offset:35968
    ds_read_b64_tr_b16 v[214:215], v2 offset:38528
    s_waitcnt lgkmcnt(5)
    ds_read_b64_tr_b16 v[216:217], v2 offset:40960
    ds_read_b64_tr_b16 v[218:219], v2 offset:43520
    ds_read_b64_tr_b16 v[220:221], v2 offset:40992
    ds_read_b64_tr_b16 v[222:223], v2 offset:43552
    ds_read_b64_tr_b16 v[224:225], v2 offset:41024
    ds_read_b64_tr_b16 v[226:227], v2 offset:43584
    ds_read_b64_tr_b16 v[228:229], v2 offset:41056
    ds_read_b64_tr_b16 v[230:231], v2 offset:43616
    ds_read_b64_tr_b16 v[232:233], v2 offset:41088
    ds_read_b64_tr_b16 v[234:235], v2 offset:43648
    s_waitcnt lgkmcnt(5)
L_cdone:
    ds_read_b32 v11, v3 offset:12
    s_waitcnt lgkmcnt(0)
    v_cmp_gt_u32 vcc, 4, v11
    s_cbranch_vccnz L_cdone
    s_mov_b64 exec, 1
    s_mov_b32 s52, 0
L_poll2:
    v_mov_b32 v11, 0
    buffer_atomic_add v11, v10, s[32:35], 0 offen sc0 sc1
    s_add_u32 s52, s52, 1
    s_cmp_ge_u32 s52, 400000
    s_waitcnt vmcnt(0)
    s_cbranch_scc1 L_poll2_out
    v_cmp_gt_u32 vcc, 32, v11
    s_cbranch_vccnz L_poll2
L_poll2_out:
    s_mov_b64 exec, -1
    buffer_load_dwordx4 v[16:19], v6, s[32:35], s47 offen sc1
    s_add_u32 s47, s47, 131072
    buffer_load_dwordx4 v[20:23], v6, s[32:35], s47 offen sc1
    s_add_u32 s47, s47, 131072
    buffer_load_dwordx4 v[24:27], v6, s[32:35], s47 offen sc1
    s_add_u32 s47, s47, 131072
    buffer_load_dwordx4 v[28:31], v6, s[32:35], s47 offen sc1
    s_add_u32 s47, s47, 131072
    buffer_load_dwordx4 v[32:35], v6, s[32:35], s47 offen sc1
    s_add_u32 s47, s47, 131072
    buffer_load_dwordx4 v[36:39], v6, s[32:35], s47 offen sc1
    s_add_u32 s47, s47, 131072
    buffer_load_dwordx4 v[40:43], v6, s[32:35], s47 offen sc1
    s_add_u32 s47, s47, 131072
    buffer_load_dwordx4 v[44:47], v6, s[32:35], s47 offen sc1
    s_add_u32 s47, s47, 131072
    buffer_load_dwordx4 v[48:51], v6, s[32:35], s47 offen sc1
    s_add_u32 s47, s47, 131072
    buffer_load_dwordx4 v[52:55], v6, s[32:35], s47 offen sc1
    s_waitcnt vmcnt(9)
    v_mfma_f32_16x16x32_bf16 v[236:239], v[56:59], v[16:19], 0
    ds_read_b64_tr_b16 v[56:57], v2 offset:46080
    ds_read_b64_tr_b16 v[58:59], v2 offset:48640
    v_mfma_f32_16x16x32_bf16 v[240:243], v[60:63], v[16:19], 0
    ds_read_b64_tr_b16 v[60:61], v2 offset:46112
    ds_read_b64_tr_b16 v[62:63], v2 offset:48672
    v_mfma_f32_16x16x32_bf16 v[244:247], v[64:67], v[16:19], 0
    ds_read_b64_tr_b16 v[64:65], v2 offset:46144
    ds_read_b64_tr_b16 v[66:67], v2 offset:48704
    v_mfma_f32_16x16x32_bf16 v[248:251], v[68:71], v[16:19], 0
    ds_read_b64_tr_b16 v[68:69], v2 offset:46176
    ds_read_b64_tr_b16 v[70:71], v2 offset:48736
    v_mfma_f32_16x16x32_bf16 v[252:255], v[72:75], v[16:19], 0
    ds_read_b64_tr_b16 v[72:73], v2 offset:46208
    ds_read_b64_tr_b16 v[74:75], v2 offset:48768
    s_waitcnt vmcnt(8)
    v_mfma_f32_16x16x32_bf16 v[236:239], v[76:79], v[20:23], v[236:239]
    v_mfma_f32_16x16x32_bf16 v[240:243], v[80:83], v[20:23], v[240:243]
    v_mfma_f32_16x16x32_bf16 v[244:247], v[84:87], v[20:23], v[244:247]
    v_mfma_f32_16x16x32_bf16 v[248:251], v[88:91], v[20:23], v[248:251]
    v_mfma_f32_16x16x32_bf16 v[252:255], v[92:95], v[20:23], v[252:255]
    s_waitcnt vmcnt(7)
    v_mfma_f32_16x16x32_bf16 v[236:239], v[96:99], v[24:27], v[236:239]
    v_mfma_f32_16x16x32_bf16 v[240:243], v[100:103], v[24:27], v[240:243]
    v_mfma_f32_16x16x32_bf16 v[244:247], v[104:107], v[24:27], v[244:247]
    v_mfma_f32_16x16x32_bf16 v[248:251], v[108:111], v[24:27], v[248:251]
    v_mfma_f32_16x16x32_bf16 v[252:255], v[112:115], v[24:27], v[252:255]
    s_waitcnt vmcnt(6)
    v_mfma_f32_16x16x32_bf16 v[236:239], v[116:119], v[28:31], v[236:239]
    v_mfma_f32_16x16x32_bf16 v[240:243], v[120:123], v[28:31], v[240:243]
    v_mfma_f32_16x16x32_bf16 v[244:247], v[124:127], v[28:31], v[244:247]
    v_mfma_f32_16x16x32_bf16 v[248:251], v[128:131], v[28:31], v[248:251]
    v_mfma_f32_16x16x32_bf16 v[252:255], v[132:135], v[28:31], v[252:255]
    s_waitcnt vmcnt(5)
    v_mfma_f32_16x16x32_bf16 v[236:239], v[136:139], v[32:35], v[236:239]
    v_mfma_f32_16x16x32_bf16 v[240:243], v[140:143], v[32:35], v[240:243]
    v_mfma_f32_16x16x32_bf16 v[244:247], v[144:147], v[32:35], v[244:247]
    v_mfma_f32_16x16x32_bf16 v[248:251], v[148:151], v[32:35], v[248:251]
    v_mfma_f32_16x16x32_bf16 v[252:255], v[152:155], v[32:35], v[252:255]
    s_waitcnt vmcnt(4)
    v_mfma_f32_16x16x32_bf16 v[236:239], v[156:159], v[36:39], v[236:239]
    v_mfma_f32_16x16x32_bf16 v[240:243], v[160:163], v[36:39], v[240:243]
    v_mfma_f32_16x16x32_bf16 v[244:247], v[164:167], v[36:39], v[244:247]
    v_mfma_f32_16x16x32_bf16 v[248:251], v[168:171], v[36:39], v[248:251]
    v_mfma_f32_16x16x32_bf16 v[252:255], v[172:175], v[36:39], v[252:255]
    s_waitcnt vmcnt(3)
    v_mfma_f32_16x16x32_bf16 v[236:239], v[176:179], v[40:43], v[236:239]
    v_mfma_f32_16x16x32_bf16 v[240:243], v[180:183], v[40:43], v[240:243]
    v_mfma_f32_16x16x32_bf16 v[244:247], v[184:187], v[40:43], v[244:247]
    v_mfma_f32_16x16x32_bf16 v[248:251], v[188:191], v[40:43], v[248:251]
    v_mfma_f32_16x16x32_bf16 v[252:255], v[192:195], v[40:43], v[252:255]
    s_waitcnt vmcnt(2)
    v_mfma_f32_16x16x32_bf16 v[236:239], v[196:199], v[44:47], v[236:239]
    v_mfma_f32_16x16x32_bf16 v[240:243], v[200:203], v[44:47], v[240:243]
    v_mfma_f32_16x16x32_bf16 v[244:247], v[204:207], v[44:47], v[244:247]
    v_mfma_f32_16x16x32_bf16 v[248:251], v[208:211], v[44:47], v[248:251]
    v_mfma_f32_16x16x32_bf16 v[252:255], v[212:215], v[44:47], v[252:255]
    s_waitcnt vmcnt(1)
    v_mfma_f32_16x16x32_bf16 v[236:239], v[216:219], v[48:51], v[236:239]
    v_mfma_f32_16x16x32_bf16 v[240:243], v[220:223], v[48:51], v[240:243]
    v_mfma_f32_16x16x32_bf16 v[244:247], v[224:227], v[48:51], v[244:247]
    v_mfma_f32_16x16x32_bf16 v[248:251], v[228:231], v[48:51], v[248:251]
    v_mfma_f32_16x16x32_bf16 v[252:255], v[232:235], v[48:51], v[252:255]
    s_waitcnt vmcnt(0) lgkmcnt(0)
    v_mfma_f32_16x16x32_bf16 v[236:239], v[56:59], v[52:55], v[236:239]
    v_mfma_f32_16x16x32_bf16 v[240:243], v[60:63], v[52:55], v[240:243]
    v_mfma_f32_16x16x32_bf16 v[244:247], v[64:67], v[52:55], v[244:247]
    v_mfma_f32_16x16x32_bf16 v[248:251], v[68:71], v[52:55], v[248:251]
    v_mfma_f32_16x16x32_bf16 v[252:255], v[72:75], v[52:55], v[252:255]
    v_mov_b32 v11, 1
    s_cmp_eq_u32 s50, 0
    s_cbranch_scc1 L_x0
    s_nop 2
    ds_write_b128 v13, v[236:239] offset:0
    ds_write_b128 v13, v[240:243] offset:1024
    ds_write_b128 v13, v[244:247] offset:2048
    s_waitcnt lgkmcnt(0)
    ds_write_b32 v15, v11 offset:32
L_pw1:
    ds_read_b32 v16, v8 offset:32
    s_waitcnt lgkmcnt(0)
    v_cmp_gt_u32 vcc, 1, v16
    s_cbranch_vccnz L_pw1
    ds_read_b128 v[16:19], v14 offset:0
    ds_read_b128 v[20:23], v14 offset:1024
    s_waitcnt lgkmcnt(1)
    v_add_f32 v16, v16, v248
    v_add_f32 v17, v17, v249
    v_add_f32 v18, v18, v250
    v_add_f32 v19, v19, v251
    s_waitcnt lgkmcnt(0)
    v_add_f32 v20, v20, v252
    v_add_f32 v21, v21, v253
    v_add_f32 v22, v22, v254
    v_add_f32 v23, v23, v255
    v_cvt_pk_bf16_f32 v40, v16, v17
    v_cvt_pk_bf16_f32 v41, v18, v19
    v_cvt_pk_bf16_f32 v42, v20, v21
    v_cvt_pk_bf16_f32 v43, v22, v23
    s_nop 1
    v_permlane16_swap_b32 v40, v42
    v_permlane16_swap_b32 v41, v43
    buffer_store_dwordx4 v[40:43], v7, s[28:31], 0 offen
    s_branch L_fin
L_x0:
    s_nop 5
    ds_write_b128 v13, v[248:251] offset:0
    ds_write_b128 v13, v[252:255] offset:1024
    s_waitcnt lgkmcnt(0)
    ds_write_b32 v15, v11 offset:32
L_pw0:
    ds_read_b32 v16, v8 offset:32
    s_waitcnt lgkmcnt(0)
    v_cmp_gt_u32 vcc, 1, v16
    s_cbranch_vccnz L_pw0
    ds_read_b128 v[16:19], v14 offset:0
    ds_read_b128 v[20:23], v14 offset:1024
    ds_read_b128 v[24:27], v14 offset:2048
    s_waitcnt lgkmcnt(2)
    v_add_f32 v16, v16, v236
    v_add_f32 v17, v17, v237
    v_add_f32 v18, v18, v238
    v_add_f32 v19, v19, v239
    s_waitcnt lgkmcnt(1)
    v_add_f32 v20, v20, v240
    v_add_f32 v21, v21, v241
    v_add_f32 v22, v22, v242
    v_add_f32 v23, v23, v243
    s_waitcnt lgkmcnt(0)
    v_add_f32 v24, v24, v244
    v_add_f32 v25, v25, v245
    v_add_f32 v26, v26, v246
    v_add_f32 v27, v27, v247
    v_cvt_pk_bf16_f32 v40, v16, v17
    v_cvt_pk_bf16_f32 v41, v18, v19
    v_cvt_pk_bf16_f32 v42, v20, v21
    v_cvt_pk_bf16_f32 v43, v22, v23
    v_cvt_pk_bf16_f32 v44, v24, v25
    v_cvt_pk_bf16_f32 v45, v26, v27
    v_permlane16_swap_b32 v40, v42
    v_permlane16_swap_b32 v41, v43
    buffer_store_dwordx4 v[40:43], v7, s[28:31], 0 offen
    buffer_store_dwordx2 v[44:45], v9, s[28:31], 0 offen offset:64
L_fin:
L_end:
    s_endpgm
L_wo:
    s_mov_b32 exec_lo, 1
    s_waitcnt lgkmcnt(0)
    ds_add_u32 v9, v28 offset:16
    s_mov_b64 exec, -1
L_wl0:
    ds_read_b32 v25, v9 offset:0
    s_waitcnt lgkmcnt(0)
    v_cmp_gt_u32 vcc, 4, v25
    s_cbranch_vccnz L_wl0
    s_add_u32 m0, s62, 83968
    s_add_u32 s51, s60, 327680
    buffer_load_dwordx4 v230, s[24:27], s51 offen lds
    s_add_u32 m0, s62, 88064
    s_nop 0
    buffer_load_dwordx4 v231, s[24:27], s51 offen lds
    s_add_u32 m0, s62, 92160
    s_nop 0
    buffer_load_dwordx4 v232, s[24:27], s51 offen lds
    s_add_u32 m0, s62, 96256
    s_nop 0
    buffer_load_dwordx4 v233, s[24:27], s51 offen lds
    s_mov_b64 exec, 0xff
    s_waitcnt vmcnt(4)
    buffer_atomic_add v28, v29, s[32:35], s53 offen sc1
    s_mov_b64 exec, -1
L_wed:
    ds_read_b32 v25, v9 offset:16
    s_waitcnt lgkmcnt(0)
    v_cmp_gt_u32 vcc, 4, v25
    s_cbranch_vccnz L_wed
    s_add_u32 m0, s62, 116736
    s_add_u32 s51, s60, 491520
    buffer_load_dwordx4 v233, s[24:27], s51 offen lds
    s_add_u32 m0, s62, 120832
    s_nop 0
    buffer_load_dwordx4 v234, s[24:27], s51 offen lds
    s_add_u32 m0, s62, 124928
    s_add_u32 s51, s60, 655360
    buffer_load_dwordx4 v230, s[24:27], s51 offen lds
    s_add_u32 m0, s62, 129024
    s_nop 0
    buffer_load_dwordx4 v231, s[24:27], s51 offen lds
    s_add_u32 m0, s62, 133120
    s_nop 0
    buffer_load_dwordx4 v232, s[24:27], s51 offen lds
    s_add_u32 m0, s62, 137216
    s_nop 0
    buffer_load_dwordx4 v233, s[24:27], s51 offen lds
    s_add_u32 m0, s62, 141312
    s_nop 0
    buffer_load_dwordx4 v234, s[24:27], s51 offen lds
    s_mov_b64 exec, 1
    s_waitcnt vmcnt(0)
    ds_add_u32 v9, v28 offset:20
    s_setprio 0
    s_branch L_p3
L_wr1:
    s_add_u32 m0, s62, 63488
    s_add_u32 s51, s60, 163840
    buffer_load_dwordx4 v230, s[24:27], s51 offen lds
    s_add_u32 m0, s62, 67584
    s_nop 0
    buffer_load_dwordx4 v231, s[24:27], s51 offen lds
    s_add_u32 m0, s62, 71680
    s_nop 0
    buffer_load_dwordx4 v232, s[24:27], s51 offen lds
    s_add_u32 m0, s62, 75776
    s_nop 0
    buffer_load_dwordx4 v233, s[24:27], s51 offen lds
    s_add_u32 m0, s62, 79872
    s_nop 0
    buffer_load_dwordx4 v234, s[24:27], s51 offen lds
L_wr2:
    s_branch L_p2_done
L_nofar:
    v_mov_b32 v80, 0xf149f2ca
    v_mov_b32 v81, 0xf149f2ca
    v_mov_b32 v82, 0xf149f2ca
    v_mov_b32 v83, 0xf149f2ca
    v_mov_b32 v84, 0xf149f2ca
    v_mov_b32 v85, 0xf149f2ca
    v_mov_b32 v86, 0xf149f2ca
    v_mov_b32 v87, 0xf149f2ca
    v_mov_b32 v88, 0xf149f2ca
    v_mov_b32 v89, 0xf149f2ca
    v_mov_b32 v90, 0xf149f2ca
    v_mov_b32 v91, 0xf149f2ca
    v_mov_b32 v92, 0xf149f2ca
    v_mov_b32 v93, 0xf149f2ca
    v_mov_b32 v94, 0xf149f2ca
    v_mov_b32 v95, 0xf149f2ca
    s_branch L_far_done
L_slow:
    v_cndmask_b32 v20, v20, 0, s[54:55]
    v_mov_b32 v25, 0xff800000
    v_mov_b32 v27, 0xf149f2ca
    s_mov_b32 s48, 0
    s_add_u32 s50, s58, 1
    s_cmp_lg_u32 s63, 0
    s_cselect_b32 s50, 9, s50
    v_mov_b32 v136, 0
    v_mov_b32 v137, 0
    v_mov_b32 v138, 0
    v_mov_b32 v139, 0
    v_mov_b32 v140, 0
    v_mov_b32 v141, 0
    v_mov_b32 v142, 0
    v_mov_b32 v143, 0
    v_mov_b32 v144, 0
    v_mov_b32 v145, 0
    v_mov_b32 v146, 0
    v_mov_b32 v147, 0
    v_mov_b32 v148, 0
    v_mov_b32 v149, 0
    v_mov_b32 v150, 0
    v_mov_b32 v151, 0
L_slow_pass:
    s_mov_b32 s52, 0
L_slow_tile:
    s_sub_u32 s49, 8, s52
    s_lshl_b32 s49, s49, 9
    v_add_u32 v10, s49, v2
    v_add_u32 v11, s49, v3
    v_add_u32 v12, s49, v4
    v_add_u32 v13, s49, v5
    ds_read_b128 v[104:107], v10
    ds_read_b64 v[108:109], v11
    ds_read_b64_tr_b16 v[120:121], v12
    ds_read_b64_tr_b16 v[122:123], v13
    ds_read_b64_tr_b16 v[124:125], v12 offset:256
    ds_read_b64_tr_b16 v[126:127], v13 offset:256
    s_waitcnt lgkmcnt(0)
    v_mfma_f32_32x32x16_bf16 v[64:79], v[104:107], v[16:19], 0
    v_mfma_f32_32x32x8_bf16 v[64:79], v[108:109], v[20:21], v[64:79]
    s_nop 15
    s_cmp_lg_u32 s52, 0
    s_cbranch_scc1 L_slow_nd
    v_bfi_b32 v64, v32, v64, v27
    v_bfi_b32 v65, v33, v65, v27
    v_bfi_b32 v66, v34, v66, v27
    v_bfi_b32 v67, v35, v67, v27
    v_bfi_b32 v68, v36, v68, v27
    v_bfi_b32 v69, v37, v69, v27
    v_bfi_b32 v70, v38, v70, v27
    v_bfi_b32 v71, v39, v71, v27
    v_bfi_b32 v72, v40, v72, v27
    v_bfi_b32 v73, v41, v73, v27
    v_bfi_b32 v74, v42, v74, v27
    v_bfi_b32 v75, v43, v75, v27
    v_bfi_b32 v76, v44, v76, v27
    v_bfi_b32 v77, v45, v77, v27
    v_bfi_b32 v78, v46, v78, v27
    v_bfi_b32 v79, v47, v79, v27
L_slow_nd:
    s_cmp_lg_u32 s52, 8
    s_cbranch_scc1 L_slow_nf
    v_bfi_b32 v64, v32, v27, v64
    v_bfi_b32 v65, v33, v27, v65
    v_bfi_b32 v66, v34, v27, v66
    v_bfi_b32 v67, v35, v27, v67
    v_bfi_b32 v68, v36, v27, v68
    v_bfi_b32 v69, v37, v27, v69
    v_bfi_b32 v70, v38, v27, v70
    v_bfi_b32 v71, v39, v27, v71
    v_bfi_b32 v72, v40, v27, v72
    v_bfi_b32 v73, v41, v27, v73
    v_bfi_b32 v74, v42, v27, v74
    v_bfi_b32 v75, v43, v27, v75
    v_bfi_b32 v76, v44, v27, v76
    v_bfi_b32 v77, v45, v27, v77
    v_bfi_b32 v78, v46, v27, v78
    v_bfi_b32 v79, v47, v27, v79
L_slow_nf:
    s_cmp_lg_u32 s48, 0
    s_cbranch_scc1 L_slow_p2
    v_max_f32 v25, v25, v64
    v_max_f32 v25, v25, v65
    v_max_f32 v25, v25, v66
    v_max_f32 v25, v25, v67
    v_max_f32 v25, v25, v68
    v_max_f32 v25, v25, v69
    v_max_f32 v25, v25, v70
    v_max_f32 v25, v25, v71
    v_max_f32 v25, v25, v72
    v_max_f32 v25, v25, v73
    v_max_f32 v25, v25, v74
    v_max_f32 v25, v25, v75
    v_max_f32 v25, v25, v76
    v_max_f32 v25, v25, v77
    v_max_f32 v25, v25, v78
    v_max_f32 v25, v25, v79
    s_branch L_slow_next
L_slow_p2:
    v_sub_f32 v64, v64, v25
    v_sub_f32 v65, v65, v25
    v_sub_f32 v66, v66, v25
    v_sub_f32 v67, v67, v25
    v_sub_f32 v68, v68, v25
    v_sub_f32 v69, v69, v25
    v_sub_f32 v70, v70, v25
    v_sub_f32 v71, v71, v25
    v_sub_f32 v72, v72, v25
    v_sub_f32 v73, v73, v25
    v_sub_f32 v74, v74, v25
    v_sub_f32 v75, v75, v25
    v_sub_f32 v76, v76, v25
    v_sub_f32 v77, v77, v25
    v_sub_f32 v78, v78, v25
    v_sub_f32 v79, v79, v25
    v_exp_f32 v64, v64
    v_exp_f32 v65, v65
    v_exp_f32 v66, v66
    v_exp_f32 v67, v67
    v_exp_f32 v68, v68
    v_exp_f32 v69, v69
    v_exp_f32 v70, v70
    v_exp_f32 v71, v71
    v_exp_f32 v72, v72
    v_exp_f32 v73, v73
    v_exp_f32 v74, v74
    v_exp_f32 v75, v75
    v_exp_f32 v76, v76
    v_exp_f32 v77, v77
    v_exp_f32 v78, v78
    v_exp_f32 v79, v79
    s_nop 0
    v_cvt_pk_bf16_f32 v96, v64, v65
    v_cvt_pk_bf16_f32 v97, v66, v67
    v_cvt_pk_bf16_f32 v98, v68, v69
    v_cvt_pk_bf16_f32 v99, v70, v71
    v_cvt_pk_bf16_f32 v100, v72, v73
    v_cvt_pk_bf16_f32 v101, v74, v75
    v_cvt_pk_bf16_f32 v102, v76, v77
    v_cvt_pk_bf16_f32 v103, v78, v79
    s_nop 1
    v_mfma_f32_32x32x16_bf16 v[136:151], v[120:123], v[96:99], v[136:151]
    v_mfma_f32_32x32x16_bf16 v[136:151], v[124:127], v[100:103], v[136:151]
    s_nop 15
L_slow_next:
    s_add_u32 s52, s52, 1
    s_cmp_lt_u32 s52, s50
    s_cbranch_scc1 L_slow_tile
    s_cmp_lg_u32 s48, 0
    s_cbranch_scc1 L_slow_done
    v_mov_b32 v26, v25
    s_nop 1
    v_permlane32_swap_b32 v25, v26
    v_max_f32 v25, v25, v26
    s_mov_b32 s48, 1
    s_branch L_slow_pass
L_slow_done:
    v_mov_b32 v25, v144
    v_mov_b32 v26, v144
    s_nop 1
    v_permlane32_swap_b32 v25, v26
    s_branch L_p2_norm
L_code_end:
.section .rodata,"a"
.p2align 6
.amdhsa_kernel standalone__sliding_block__prompt_kernel
  .amdhsa_next_free_vgpr 256
  .amdhsa_next_free_sgpr 102
  .amdhsa_accum_offset 256
  .amdhsa_group_segment_fixed_size 0
  .amdhsa_kernarg_size 48
  .amdhsa_user_sgpr_count 2
  .amdhsa_user_sgpr_kernarg_segment_ptr 1
  .amdhsa_system_sgpr_workgroup_id_x 1
.end_amdhsa_kernel
```
